```python
import torch

def _softmax(x, axis=-1):
    return torch.softmax(x, dim=axis)
def _gelu(x):
    return torch.nn.functional.gelu(x, approximate="tanh")
def _silu(x):
    return torch.nn.functional.silu(x)
def _sigmoid(x):
    return torch.sigmoid(x)
def _layernorm(x, axis=-1, eps=1e-5):
    m = x.mean(dim=axis, keepdim=True)
    v = x.var(dim=axis, keepdim=True, unbiased=False)
    return (x - m) / torch.sqrt(v + eps)
def _scatter_add(tgt, idx, src, axis=0):
    return tgt.clone().index_add_(axis, idx, src)
def _segment_sum(src, seg, n):
    out = torch.zeros((n,) + src.shape[1:], dtype=src.dtype)
    return out.index_add_(0, seg, src)
def _pad(x, pw):
    flat = tuple(v for pair in reversed(pw) for v in pair)
    return torch.nn.functional.pad(x, flat)

kernel_name = 'gated_mix__sliding_block_cached__glu_gated_reglu__decode'

def setup_inputs():

    _w = (lambda a: (lambda t: t.to(torch.bfloat16) if t.is_floating_point() else t)(torch.as_tensor(a)))
    def _A_setup():
        B, Sq, D = 8, 1, 1024
        Hq, Hkv, Sk, Dh = 32, 4, 4096, 128
        assert Hq % Hkv == 0, (Hq, Hkv)
        return {
            "x": _w((lambda *s: torch.randn(*s, dtype=torch.bfloat16) * 0.05)(B, Sq, D)),
            "k_cache": _w((lambda *s: torch.randn(*s, dtype=torch.bfloat16) * 3.2)(B, Hkv, Sk, Dh)),
            "v_cache": _w((lambda *s: torch.randn(*s, dtype=torch.bfloat16) * 0.05)(B, Hkv, Sk, Dh)),
            "wq": _w((lambda *s: torch.randn(*s, dtype=torch.bfloat16) * 3.2)(D, Hq * Dh) * (D ** -0.5)),
            "wo": _w((lambda *s: torch.randn(*s, dtype=torch.bfloat16) * 0.05)(Hq * Dh, D) * ((Hq * Dh) ** -0.5)),
        }
    _A_in = _A_setup()

    def _B_setup():
        B, S, D, F = 8, 1, 1024, 3584
        return {
            "x": _w((lambda *s: torch.randn(*s, dtype=torch.bfloat16) * 0.05)(B, S, D)),
            "W_gate": _w((lambda *s: torch.randn(*s, dtype=torch.bfloat16) * 0.2)(D, F) * (2.0 / D) ** 0.5),
            "W_up": _w((lambda *s: torch.randn(*s, dtype=torch.bfloat16) * 0.2)(D, F) * (2.0 / D) ** 0.5),
            "W_down": _w((lambda *s: torch.randn(*s, dtype=torch.bfloat16) * 0.2)(F, D) * (1.0 / F) ** 0.5),
        }
    _B_in = _B_setup()

    return {
        "A_x": _A_in["x"],
        "A_k_cache": _A_in["k_cache"],
        "A_v_cache": _A_in["v_cache"],
        "A_wq": _A_in["wq"],
        "A_wo": _A_in["wo"],
        "B_x": _B_in["x"],
        "B_W_gate": _B_in["W_gate"],
        "B_W_up": _B_in["W_up"],
        "B_W_down": _B_in["W_down"],
        "gate_w": _w((lambda *s: torch.randn(*s, dtype=torch.bfloat16) * 0.05)(1024) * 16.0),
    }

def reference(A_x, A_k_cache, A_v_cache, A_wq, A_wo, B_x, B_W_gate, B_W_up, B_W_down, gate_w):
    def _A_ref(x, k_cache, v_cache, wq, wo):
        B, Sq, D = x.shape
        Hq, Dh = 32, 128
        Hkv, Sk = k_cache.shape[1], k_cache.shape[2]
        W = min(4096, max(256, Sk // 4))
        rep = Hq // Hkv
        q = (lambda x, *d: x.permute(*d))((x @ wq).reshape(B, Sq, Hq, Dh), 0, 2, 1, 3)
        k = (lambda x, n, axis: torch.repeat_interleave(x, n, dim=axis))(k_cache[:, :, Sk - W:, :], rep, axis=1)
        v = (lambda x, n, axis: torch.repeat_interleave(x, n, dim=axis))(v_cache[:, :, Sk - W:, :], rep, axis=1)
        scores = torch.einsum("bhqd,bhkd->bhqk", q, k) * (Dh ** -0.5)
        p = _softmax(scores, axis=-1)
        o = torch.einsum("bhqk,bhkd->bhqd", p, v)
        return (lambda x, *d: x.permute(*d))(o, 0, 2, 1, 3).reshape(B, Sq, Hq * Dh) @ wo

    def _B_ref(x, W_gate, W_up, W_down):
        gate = torch.einsum("bsd,df->bsf", x, W_gate)
        up = torch.einsum("bsd,df->bsf", x, W_up)
        gate = gate * (lambda x, dt: x.to(dt))(gate > 0, gate.dtype)
        h = gate * up
        return torch.einsum("bsf,fd->bsd", h, W_down)

    x = A_x
    g = _sigmoid((x * gate_w).sum(-1, keepdims=True))
    a = _A_ref(x, A_k_cache, A_v_cache, A_wq, A_wo)
    b = _B_ref(x, B_W_gate, B_W_up, B_W_down)
    return g * a + (1 - g) * b
```

```asm
; @launch grid=(256,1,1) block=(704,1,1) lds=147840
.amdgcn_target "amdgcn-amd-amdhsa--gfx950"
.text
.globl gated_mix__sliding_block_cached__glu_gated_reglu__decode_kernel
.p2align 12
.fill 832, 4, 0xbf810000
.p2align 8
.type gated_mix__sliding_block_cached__glu_gated_reglu__decode_kernel,@function
gated_mix__sliding_block_cached__glu_gated_reglu__decode_kernel:
    s_load_dwordx16 s[16:31], s[0:1], 0
    s_load_dwordx8 s[32:39], s[0:1], 64
    s_load_dwordx2 s[40:41], s[0:1], 96
    s_cmp_ge_u32 s2, 256
    s_cbranch_scc1 L_end
    v_lshrrev_b32 v1, 6, v0
    v_and_b32 v0, 63, v0
    v_readfirstlane_b32 s3, v1
    s_and_b32 s42, s2, 7
    s_lshr_b32 s43, s2, 3
    s_lshr_b32 s47, s42, 1
    s_and_b32 s66, s42, 1
    s_add_u32 s15, s43, s2
    s_lshl_b32 s64, s42, 1
    s_sub_u32 s64, s43, s64
    s_sub_u32 s64, s64, 4
    s_bfe_u32 s65, s64, 0x20002
    s_and_b32 s64, s64, 3
    s_lshl2_add_u32 s45, s64, s65
    s_cmp_ge_u32 s43, 16
    s_cselect_b32 s45, s43, s45
    s_lshr_b32 s64, s45, 3
    s_lshl2_add_u32 s100, s66, s64
    s_cmp_lg_u32 s3, 0
    s_cbranch_scc1 L_notloader
    s_setprio 3
    v_mov_b32 v9, 147456
    v_mov_b32 v10, 0xff7fffff
    v_cmp_gt_u32 vcc, 16, v0
    v_lshl_add_u32 v11, v0, 2, v9
    v_lshrrev_b32 v2, 4, v0
    v_cndmask_b32 v10, v10, 0, vcc
    ds_write_b32 v11, v10
    v_bfe_u32 v3, v0, 1, 3
    v_xor_b32 v3, v3, v2
    v_lshlrev_b32 v3, 5, v3
    v_and_b32 v4, 1, v0
    v_lshl_or_b32 v3, v4, 4, v3
    v_xor_b32 v4, 0x80, v3
    v_lshl_add_u32 v5, v2, 13, v3
    v_lshl_add_u32 v6, v2, 13, v4
    s_mov_b32 s11, 0x20000
    s_and_b32 s64, s45, 7
    s_lshl3_add_u32 s64, s47, s64
    s_lshl_b32 s64, s64, 8
    s_lshl_b32 s4, s100, 20
    s_add_u32 s4, s4, s64
    s_mov_b32 s10, 8388608
    s_mov_b32 s6, 3
    s_mov_b32 s5, 32768
    s_mov_b32 s14, s4
    s_and_b32 s64, s15, 7
    s_lshl_b32 s65, s64, 17
    s_add_u32 s4, s4, s65
    s_lshl_b32 s64, s64, 12
    s_add_u32 m0, s64, 98304
    s_mov_b32 s7, 3
    s_waitcnt lgkmcnt(0)
    s_mov_b64 s[8:9], s[22:23]
    buffer_load_dwordx4 v5, s[8:11], s4 offen nt lds
    s_add_u32 m0, m0, 1024
    s_add_u32 s4, s4, s5
    buffer_load_dwordx4 v5, s[8:11], s4 offen nt lds
    s_add_u32 m0, m0, 1024
    s_add_u32 s4, s4, s5
    buffer_load_dwordx4 v6, s[8:11], s4 offen nt lds
    s_add_u32 m0, m0, 1024
    s_add_u32 s4, s4, s5
    buffer_load_dwordx4 v6, s[8:11], s4 offen nt lds
    s_add_u32 m0, m0, 1024
    s_add_u32 s4, s4, s5
    s_cmp_eq_u32 m0, 131072
    s_cselect_b32 m0, 98304, m0
    s_cselect_b32 s4, s14, s4
    buffer_load_dwordx4 v5, s[8:11], s4 offen nt lds
    s_add_u32 m0, m0, 1024
    s_add_u32 s4, s4, s5
    buffer_load_dwordx4 v5, s[8:11], s4 offen nt lds
    s_add_u32 m0, m0, 1024
    s_add_u32 s4, s4, s5
    buffer_load_dwordx4 v6, s[8:11], s4 offen nt lds
    s_add_u32 m0, m0, 1024
    s_add_u32 s4, s4, s5
    buffer_load_dwordx4 v6, s[8:11], s4 offen nt lds
    s_add_u32 m0, m0, 1024
    s_add_u32 s4, s4, s5
    s_cmp_eq_u32 m0, 131072
    s_cselect_b32 m0, 98304, m0
    s_cselect_b32 s4, s14, s4
    s_barrier
    s_mov_b32 s6, 2
L_top_loop:
    buffer_load_dwordx4 v5, s[8:11], s4 offen nt lds
    s_add_u32 m0, m0, 1024
    s_add_u32 s4, s4, s5
    buffer_load_dwordx4 v5, s[8:11], s4 offen nt lds
    s_add_u32 m0, m0, 1024
    s_add_u32 s4, s4, s5
    buffer_load_dwordx4 v6, s[8:11], s4 offen nt lds
    s_add_u32 m0, m0, 1024
    s_add_u32 s4, s4, s5
    buffer_load_dwordx4 v6, s[8:11], s4 offen nt lds
    s_add_u32 m0, m0, 1024
    s_add_u32 s4, s4, s5
    s_cmp_eq_u32 m0, 131072
    s_cselect_b32 m0, 98304, m0
    s_cselect_b32 s4, s14, s4
    buffer_load_dwordx4 v5, s[8:11], s4 offen nt lds
    s_add_u32 m0, m0, 1024
    s_add_u32 s4, s4, s5
    buffer_load_dwordx4 v5, s[8:11], s4 offen nt lds
    s_add_u32 m0, m0, 1024
    s_add_u32 s4, s4, s5
    buffer_load_dwordx4 v6, s[8:11], s4 offen nt lds
    s_add_u32 m0, m0, 1024
    s_add_u32 s4, s4, s5
    buffer_load_dwordx4 v6, s[8:11], s4 offen nt lds
    s_add_u32 m0, m0, 1024
    s_add_u32 s4, s4, s5
    s_cmp_eq_u32 m0, 131072
    s_cselect_b32 m0, 98304, m0
    s_cselect_b32 s4, s14, s4
    s_sub_u32 s6, s6, 1
    s_cmp_lg_u32 s6, 0
    s_cbranch_scc1 L_top_loop
    s_branch L_loader2
L_notloader:
    s_cmp_eq_u32 s3, 10
    s_cbranch_scc1 L_loader2
    s_cmp_gt_u32 s3, 2
    s_cbranch_scc1 L_cpf_done
    s_cmp_lg_u32 s43, 14
    s_cbranch_scc1 L_cpf_done
    s_getpc_b64 s[4:5]
L_pc:
    s_lshl_b32 s64, s3, 13
    s_sub_u32 s64, s64, 8192
    v_lshl_add_u32 v1, v0, 7, s64
    v_cmp_gt_u32 vcc, L_end-L_pc, v1
    s_and_saveexec_b64 s[6:7], vcc
    s_cbranch_execz L_cpf_done2
    global_load_dword v127, v1, s[4:5]
L_cpf_done2:
    s_mov_b64 exec, -1
L_cpf_done:
    s_barrier
    s_branch L_cons
L_loader2:
    s_mul_i32 s46, s42, 14
    s_add_u32 s46, s46, s43
    s_mov_b32 s62, 0
    s_cmp_ge_u32 s43, 16
    s_cbranch_scc1 L_d2m_2
    s_cmp_ge_u32 s43, 14
    s_cselect_b32 s44, 2, 1
    s_sub_u32 s64, s42, 3
    s_cmp_lt_u32 s64, 2
    s_cselect_b32 s64, 2, 0
    s_sub_u32 s64, s43, s64
    s_bfe_u32 s50, s64, 0x10001
    s_lshl1_add_u32 s49, s42, s50
    s_and_b32 s50, s64, 1
    s_add_u32 s64, s64, 8
    s_bfe_u32 s64, s64, 0x20002
    s_lshl2_add_u32 s50, s50, s64
    s_lshl_b32 s101, s49, 3
    s_add_u32 s53, s43, s42
    s_and_b32 s53, s53, 7
    s_branch L_d2_1
L_d2m_2:
    s_mov_b32 s44, 0
    s_and_b32 s64, s42, 1
    s_bfe_u32 s51, s43, 0x20002
    s_lshl2_add_u32 s51, s64, s51
    s_and_b32 s48, s43, 3
    s_bfe_u32 s64, s43, 0x10003
    s_lshl1_add_u32 s49, s42, s64
    s_mul_i32 s101, s49, 7
    s_and_b32 s53, s43, 7
    s_cmp_eq_u32 s53, 7
    s_cselect_b32 s53, 3, s53
    s_add_u32 s50, s43, 1
    s_and_b32 s50, s50, 7
L_d2_1:
    s_cmp_eq_u32 s3, 0
    s_cbranch_scc1 L_loader3
    v_mov_b32 v9, 147456
    s_barrier
    s_waitcnt lgkmcnt(0)
    s_lshl_b32 s64, s2, 6
    s_load_dword s8, s[16:17], s64
    s_lshl_b32 s64, s43, 6
    s_load_dword s9, s[34:35], s64
    s_lshl_b32 s64, s101, 16
    s_lshl_b32 s65, s50, 8
    s_add_u32 s64, s64, s65
    s_cmp_ge_u32 s43, 16
    s_cbranch_scc1 L_stM
    s_load_dword s4, s[24:25], s64
    s_cmp_eq_u32 s44, 2
    s_cbranch_scc1 L_stD
    s_bitcmp0_b32 s46, 1
    s_cselect_b64 s[12:13], s[28:29], s[30:31]
    s_and_b32 s64, s46, 1
    s_mul_i32 s64, s64, 3670016
    s_lshr_b32 s65, s46, 2
    s_lshl_b32 s65, s65, 8
    s_add_u32 s64, s64, s65
    s_load_dword s5, s[12:13], s64
    s_add_u32 s64, s64, 1827840
    s_load_dword s6, s[12:13], s64
    s_add_u32 s64, s64, 1827840
    s_load_dword s7, s[12:13], s64
    s_add_u32 s64, s64, 1827840
    s_branch L_stD
L_stM:
    s_lshl2_add_u32 s65, s51, s47
    s_lshl4_add_u32 s65, s65, s48
    s_add_u32 s65, s65, 12
    s_lshl_b32 s65, s65, 16
    s_load_dword s7, s[18:19], s65
    s_load_dword s5, s[20:21], s65
    s_load_dword s4, s[32:33], s64
    s_add_u32 s64, s64, 456704
    s_load_dword s10, s[32:33], s64
    s_lshl_b32 s64, s43, 9
    s_lshl_b32 s65, s42, 6
    s_add_u32 s64, s64, s65
    s_load_dword s6, s[36:37], s64 glc
L_stD:
    s_waitcnt lgkmcnt(0)
    s_branch L_notif
L_loader3:
    v_and_b32 v7, 7, v0
    v_lshlrev_b32 v7, 11, v7
    v_lshrrev_b32 v8, 3, v0
    v_lshl_add_u32 v7, v8, 4, v7
    s_mov_b64 s[68:69], s[16:17]
    s_mov_b32 s70, 16384
    s_mov_b32 s71, 0x20000
    s_lshl_b32 s66, s100, 8
    s_mov_b32 s12, m0
    s_mov_b32 m0, 131072
    s_nop 0
    buffer_load_dwordx4 v7, s[68:71], s66 offen lds
    s_mov_b32 m0, 131968
    s_nop 0
    buffer_load_dwordx4 v7, s[68:71], s66 offen offset:128 lds
    s_mov_b32 m0, s12
    s_cmp_ge_u32 s43, 16
    s_cbranch_scc1 L_ld_M
    s_cmp_eq_u32 s44, 2
    s_cbranch_scc1 L_ld_C
    s_sub_u32 s64, s7, 3
    s_max_i32 s62, s64, s62
    v_mov_b32 v10, s62
    s_waitcnt vmcnt(24)
    ds_write_b32 v9, v10 offset:0
    buffer_load_dwordx4 v5, s[8:11], s4 offen nt lds
    s_add_u32 m0, m0, 1024
    s_add_u32 s4, s4, s5
    buffer_load_dwordx4 v5, s[8:11], s4 offen nt lds
    s_add_u32 m0, m0, 1024
    s_add_u32 s4, s4, s5
    s_waitcnt vmcnt(24)
    buffer_load_dwordx4 v6, s[8:11], s4 offen nt lds
    s_add_u32 m0, m0, 1024
    s_add_u32 s4, s4, s5
    buffer_load_dwordx4 v6, s[8:11], s4 offen nt lds
    s_add_u32 m0, m0, 1024
    s_add_u32 s4, s4, s5
    s_cmp_eq_u32 m0, 131072
    s_cselect_b32 m0, 98304, m0
    s_cselect_b32 s4, s14, s4
    s_waitcnt vmcnt(24)
    buffer_load_dwordx4 v5, s[8:11], s4 offen nt lds
    s_add_u32 m0, m0, 1024
    s_add_u32 s4, s4, s5
    buffer_load_dwordx4 v5, s[8:11], s4 offen nt lds
    s_add_u32 m0, m0, 1024
    s_add_u32 s4, s4, s5
    s_waitcnt vmcnt(24)
    buffer_load_dwordx4 v6, s[8:11], s4 offen nt lds
    s_add_u32 m0, m0, 1024
    s_add_u32 s4, s4, s5
    buffer_load_dwordx4 v6, s[8:11], s4 offen nt lds
    s_add_u32 m0, m0, 1024
    s_add_u32 s4, s4, s5
    s_cmp_eq_u32 m0, 131072
    s_cselect_b32 m0, 98304, m0
    s_cselect_b32 s4, s14, s4
    s_add_u32 s7, s7, 1
    s_and_b32 s15, s15, 6
    s_mov_b32 s12, s15
    s_and_b32 s65, s46, 1
    s_mov_b32 s5, 28672
    v_mul_u32_u24 v8, 7168, v2
    v_add_u32 v5, v8, v3
    v_add_u32 v6, v8, v4
    s_mov_b32 s13, 1835008
    s_mul_i32 s4, s65, 3670016
    s_lshr_b32 s64, s46, 2
    s_lshl_b32 s64, s64, 8
    s_add_u32 s4, s4, s64
    s_mul_i32 s64, s15, 229376
    s_add_u32 s4, s4, s64
    s_bitcmp0_b32 s46, 1
    s_cselect_b64 s[8:9], s[28:29], s[30:31]
    s_mov_b32 s10, 7340032
    s_mov_b32 m0, 0
    s_mov_b32 s6, 6
L_ld_4:
    s_sub_u32 s64, s7, 3
    s_max_i32 s62, s64, s62
    v_mov_b32 v10, s62
    s_waitcnt vmcnt(24)
    ds_write_b32 v9, v10 offset:0
    buffer_load_dwordx4 v5, s[8:11], s4 offen nt lds
    s_add_u32 m0, m0, 1024
    s_add_u32 s4, s4, s5
    buffer_load_dwordx4 v5, s[8:11], s4 offen nt lds
    s_add_u32 m0, m0, 1024
    s_add_u32 s4, s4, s5
    s_waitcnt vmcnt(24)
    buffer_load_dwordx4 v6, s[8:11], s4 offen nt lds
    s_add_u32 m0, m0, 1024
    s_add_u32 s4, s4, s5
    buffer_load_dwordx4 v6, s[8:11], s4 offen nt lds
    s_add_u32 m0, m0, 1024
    s_add_u32 s4, s4, s5
    s_waitcnt vmcnt(24)
    buffer_load_dwordx4 v5, s[8:11], s4 offen nt lds
    s_add_u32 m0, m0, 1024
    s_add_u32 s4, s4, s5
    buffer_load_dwordx4 v5, s[8:11], s4 offen nt lds
    s_add_u32 m0, m0, 1024
    s_add_u32 s4, s4, s5
    s_waitcnt vmcnt(24)
    buffer_load_dwordx4 v6, s[8:11], s4 offen nt lds
    s_add_u32 m0, m0, 1024
    s_add_u32 s4, s4, s5
    buffer_load_dwordx4 v6, s[8:11], s4 offen nt lds
    s_add_u32 m0, m0, 1024
    s_add_u32 s4, s4, s5
    s_add_u32 s12, s12, 1
    s_and_b32 s12, s12, 7
    s_cselect_b32 s64, 0, s13
    s_sub_u32 s4, s4, s64
    s_add_u32 s7, s7, 1
    s_sub_u32 s6, s6, 1
    s_cmp_lg_u32 s6, 0
    s_cbranch_scc1 L_ld_4
    s_and_b32 s66, s46, 1
    s_lshl_b32 s66, s66, 10
    s_add_u32 s64, s15, 0
    s_and_b32 s64, s64, 7
    s_lshl_b32 s64, s64, 6
    s_add_u32 s64, s64, s66
    s_mov_b32 m0, 133120
    s_nop 0
    buffer_load_dwordx4 v7, s[68:71], s64 offen offset:0 lds
    s_mov_b32 m0, 136704
    s_nop 0
    buffer_load_dwordx4 v7, s[68:71], s64 offen offset:512 lds
    s_add_u32 s64, s15, 2
    s_and_b32 s64, s64, 7
    s_lshl_b32 s64, s64, 6
    s_add_u32 s64, s64, s66
    s_mov_b32 m0, 134144
    s_nop 0
    buffer_load_dwordx4 v7, s[68:71], s64 offen offset:0 lds
    s_mov_b32 m0, 137728
    s_nop 0
    buffer_load_dwordx4 v7, s[68:71], s64 offen offset:512 lds
    s_add_u32 s64, s15, 4
    s_and_b32 s64, s64, 7
    s_lshl_b32 s64, s64, 6
    s_add_u32 s64, s64, s66
    s_mov_b32 m0, 135168
    s_nop 0
    buffer_load_dwordx4 v7, s[68:71], s64 offen offset:0 lds
    s_mov_b32 m0, 138752
    s_nop 0
    buffer_load_dwordx4 v7, s[68:71], s64 offen offset:512 lds
    s_add_u32 s64, s15, 6
    s_and_b32 s64, s64, 7
    s_lshl_b32 s64, s64, 6
    s_add_u32 s64, s64, s66
    s_mov_b32 m0, 136192
    s_nop 0
    buffer_load_dwordx4 v7, s[68:71], s64 offen offset:0 lds
    s_mov_b32 m0, 139776
    s_nop 0
    buffer_load_dwordx4 v7, s[68:71], s64 offen offset:512 lds
    s_mov_b32 m0, 49152
    s_mov_b32 s6, 2
L_ld_5:
    s_sub_u32 s64, s7, 3
    s_max_i32 s62, s64, s62
    v_mov_b32 v10, s62
    s_waitcnt vmcnt(24)
    ds_write_b32 v9, v10 offset:0
    buffer_load_dwordx4 v5, s[8:11], s4 offen nt lds
    s_add_u32 m0, m0, 1024
    s_add_u32 s4, s4, s5
    buffer_load_dwordx4 v5, s[8:11], s4 offen nt lds
    s_add_u32 m0, m0, 1024
    s_add_u32 s4, s4, s5
    s_waitcnt vmcnt(24)
    buffer_load_dwordx4 v6, s[8:11], s4 offen nt lds
    s_add_u32 m0, m0, 1024
    s_add_u32 s4, s4, s5
    buffer_load_dwordx4 v6, s[8:11], s4 offen nt lds
    s_add_u32 m0, m0, 1024
    s_add_u32 s4, s4, s5
    s_waitcnt vmcnt(24)
    buffer_load_dwordx4 v5, s[8:11], s4 offen nt lds
    s_add_u32 m0, m0, 1024
    s_add_u32 s4, s4, s5
    buffer_load_dwordx4 v5, s[8:11], s4 offen nt lds
    s_add_u32 m0, m0, 1024
    s_add_u32 s4, s4, s5
    s_waitcnt vmcnt(24)
    buffer_load_dwordx4 v6, s[8:11], s4 offen nt lds
    s_add_u32 m0, m0, 1024
    s_add_u32 s4, s4, s5
    buffer_load_dwordx4 v6, s[8:11], s4 offen nt lds
    s_add_u32 m0, m0, 1024
    s_add_u32 s4, s4, s5
    s_add_u32 s12, s12, 1
    s_and_b32 s12, s12, 7
    s_cselect_b32 s64, 0, s13
    s_sub_u32 s4, s4, s64
    s_add_u32 s7, s7, 1
    s_sub_u32 s6, s6, 1
    s_cmp_lg_u32 s6, 0
    s_cbranch_scc1 L_ld_5
L_w_6:
    ds_read_b32 v11, v9 offset:44
    s_waitcnt lgkmcnt(0)
    v_readfirstlane_b32 s64, v11
    s_cmp_ge_u32 s64, 8
    s_cbranch_scc0 L_w_6
    s_add_u32 s4, s4, s13
    s_mov_b32 m0, 65536
    s_mov_b32 s6, 8
L_ld_7:
    s_sub_u32 s64, s7, 3
    s_max_i32 s62, s64, s62
    v_mov_b32 v10, s62
    s_waitcnt vmcnt(24)
    ds_write_b32 v9, v10 offset:0
    buffer_load_dwordx4 v5, s[8:11], s4 offen nt lds
    s_add_u32 m0, m0, 1024
    s_add_u32 s4, s4, s5
    buffer_load_dwordx4 v5, s[8:11], s4 offen nt lds
    s_add_u32 m0, m0, 1024
    s_add_u32 s4, s4, s5
    s_waitcnt vmcnt(24)
    buffer_load_dwordx4 v6, s[8:11], s4 offen nt lds
    s_add_u32 m0, m0, 1024
    s_add_u32 s4, s4, s5
    buffer_load_dwordx4 v6, s[8:11], s4 offen nt lds
    s_add_u32 m0, m0, 1024
    s_add_u32 s4, s4, s5
    s_waitcnt vmcnt(24)
    buffer_load_dwordx4 v5, s[8:11], s4 offen nt lds
    s_add_u32 m0, m0, 1024
    s_add_u32 s4, s4, s5
    buffer_load_dwordx4 v5, s[8:11], s4 offen nt lds
    s_add_u32 m0, m0, 1024
    s_add_u32 s4, s4, s5
    s_waitcnt vmcnt(24)
    buffer_load_dwordx4 v6, s[8:11], s4 offen nt lds
    s_add_u32 m0, m0, 1024
    s_add_u32 s4, s4, s5
    buffer_load_dwordx4 v6, s[8:11], s4 offen nt lds
    s_add_u32 m0, m0, 1024
    s_add_u32 s4, s4, s5
    s_add_u32 s12, s12, 1
    s_and_b32 s12, s12, 7
    s_cselect_b32 s64, 0, s13
    s_sub_u32 s4, s4, s64
    s_add_u32 s7, s7, 1
    s_sub_u32 s6, s6, 1
    s_cmp_lg_u32 s6, 0
    s_cbranch_scc1 L_ld_7
L_w_8:
    ds_read_b32 v11, v9 offset:48
    s_waitcnt lgkmcnt(0)
    v_readfirstlane_b32 s64, v11
    s_cmp_ge_u32 s64, 8
    s_cbranch_scc0 L_w_8
    s_mov_b32 s5, 8192
    v_lshl_add_u32 v5, v2, 11, v3
    v_lshl_add_u32 v6, v2, 11, v4
    s_mov_b32 s13, 524288
    s_mov_b64 s[8:9], s[24:25]
    s_mov_b32 s10, 8388608
    s_mov_b32 s12, s53
    s_add_u32 s4, s101, s53
    s_lshl_b32 s4, s4, 16
    s_lshl_b32 s64, s50, 8
    s_add_u32 s4, s4, s64
    s_mov_b32 m0, 0
    s_mov_b32 s6, 8
L_ld_9:
    s_waitcnt vmcnt(22)
    buffer_load_dwordx4 v5, s[8:11], s4 offen nt lds
    s_add_u32 m0, m0, 1024
    s_add_u32 s4, s4, s5
    buffer_load_dwordx4 v5, s[8:11], s4 offen nt lds
    s_add_u32 m0, m0, 1024
    s_add_u32 s4, s4, s5
    s_waitcnt vmcnt(22)
    buffer_load_dwordx4 v6, s[8:11], s4 offen nt lds
    s_add_u32 m0, m0, 1024
    s_add_u32 s4, s4, s5
    buffer_load_dwordx4 v6, s[8:11], s4 offen nt lds
    s_add_u32 m0, m0, 1024
    s_add_u32 s4, s4, s5
    s_waitcnt vmcnt(22)
    buffer_load_dwordx4 v5, s[8:11], s4 offen nt lds
    s_add_u32 m0, m0, 1024
    s_add_u32 s4, s4, s5
    buffer_load_dwordx4 v5, s[8:11], s4 offen nt lds
    s_add_u32 m0, m0, 1024
    s_add_u32 s4, s4, s5
    s_sub_u32 s64, s7, 2
    s_max_i32 s62, s64, s62
    v_mov_b32 v10, s62
    s_waitcnt vmcnt(22)
    ds_write_b32 v9, v10 offset:0
    buffer_load_dwordx4 v6, s[8:11], s4 offen nt lds
    s_add_u32 m0, m0, 1024
    s_add_u32 s4, s4, s5
    buffer_load_dwordx4 v6, s[8:11], s4 offen nt lds
    s_add_u32 m0, m0, 1024
    s_add_u32 s4, s4, s5
    s_add_u32 s12, s12, 1
    s_and_b32 s12, s12, 7
    s_cselect_b32 s64, 0, s13
    s_sub_u32 s4, s4, s64
    s_add_u32 s7, s7, 1
    s_sub_u32 s6, s6, 1
    s_cmp_lg_u32 s6, 0
    s_cbranch_scc1 L_ld_9
    s_sub_u32 s64, s7, 3
    s_max_i32 s62, s64, s62
    v_mov_b32 v10, s62
    s_waitcnt vmcnt(24)
    ds_write_b32 v9, v10 offset:0
    s_sub_u32 s64, s7, 2
    s_max_i32 s62, s64, s62
    v_mov_b32 v10, s62
    s_waitcnt vmcnt(16)
    ds_write_b32 v9, v10 offset:0
    s_sub_u32 s64, s7, 1
    s_max_i32 s62, s64, s62
    v_mov_b32 v10, s62
    s_waitcnt vmcnt(8)
    ds_write_b32 v9, v10 offset:0
    s_sub_u32 s64, s7, 0
    s_max_i32 s62, s64, s62
    v_mov_b32 v10, s62
    s_waitcnt vmcnt(0)
    ds_write_b32 v9, v10 offset:0
    s_branch L_ld_end
L_ld_C:
    s_waitcnt vmcnt(20)
    buffer_load_dwordx4 v5, s[8:11], s4 offen nt lds
    s_add_u32 m0, m0, 1024
    s_add_u32 s4, s4, s5
    buffer_load_dwordx4 v5, s[8:11], s4 offen nt lds
    s_add_u32 m0, m0, 1024
    s_add_u32 s4, s4, s5
    s_waitcnt vmcnt(20)
    buffer_load_dwordx4 v6, s[8:11], s4 offen nt lds
    s_add_u32 m0, m0, 1024
    s_add_u32 s4, s4, s5
    buffer_load_dwordx4 v6, s[8:11], s4 offen nt lds
    s_add_u32 m0, m0, 1024
    s_add_u32 s4, s4, s5
    s_cmp_eq_u32 m0, 131072
    s_cselect_b32 m0, 98304, m0
    s_cselect_b32 s4, s14, s4
    s_sub_u32 s64, s7, 2
    s_max_i32 s62, s64, s62
    v_mov_b32 v10, s62
    s_waitcnt vmcnt(20)
    ds_write_b32 v9, v10 offset:0
    buffer_load_dwordx4 v5, s[8:11], s4 offen nt lds
    s_add_u32 m0, m0, 1024
    s_add_u32 s4, s4, s5
    buffer_load_dwordx4 v5, s[8:11], s4 offen nt lds
    s_add_u32 m0, m0, 1024
    s_add_u32 s4, s4, s5
    s_waitcnt vmcnt(20)
    buffer_load_dwordx4 v6, s[8:11], s4 offen nt lds
    s_add_u32 m0, m0, 1024
    s_add_u32 s4, s4, s5
    buffer_load_dwordx4 v6, s[8:11], s4 offen nt lds
    s_add_u32 m0, m0, 1024
    s_add_u32 s4, s4, s5
    s_cmp_eq_u32 m0, 131072
    s_cselect_b32 m0, 98304, m0
    s_cselect_b32 s4, s14, s4
    s_add_u32 s7, s7, 1
    s_sub_u32 s64, s7, 3
    s_max_i32 s62, s64, s62
    v_mov_b32 v10, s62
    s_waitcnt vmcnt(24)
    ds_write_b32 v9, v10 offset:0
    s_sub_u32 s64, s7, 2
    s_max_i32 s62, s64, s62
    v_mov_b32 v10, s62
    s_waitcnt vmcnt(16)
    ds_write_b32 v9, v10 offset:0
    s_sub_u32 s64, s7, 1
    s_max_i32 s62, s64, s62
    v_mov_b32 v10, s62
    s_waitcnt vmcnt(8)
    ds_write_b32 v9, v10 offset:0
    s_sub_u32 s64, s7, 0
    s_max_i32 s62, s64, s62
    v_mov_b32 v10, s62
    s_waitcnt vmcnt(0)
    ds_write_b32 v9, v10 offset:0
    s_mov_b32 s5, 8192
    v_lshl_add_u32 v5, v2, 11, v3
    v_lshl_add_u32 v6, v2, 11, v4
    s_mov_b32 s13, 524288
    s_mov_b64 s[8:9], s[24:25]
    s_mov_b32 s10, 8388608
    s_mov_b32 s12, s53
    s_add_u32 s4, s101, s53
    s_lshl_b32 s4, s4, 16
    s_lshl_b32 s64, s50, 8
    s_add_u32 s4, s4, s64
    s_mov_b32 s7, 20
    s_mov_b32 m0, 0
    s_mov_b32 s6, 3
L_ld_11:
    s_waitcnt vmcnt(4)
    buffer_load_dwordx4 v5, s[8:11], s4 offen nt lds
    s_add_u32 m0, m0, 1024
    s_add_u32 s4, s4, s5
    buffer_load_dwordx4 v5, s[8:11], s4 offen nt lds
    s_add_u32 m0, m0, 1024
    s_add_u32 s4, s4, s5
    s_waitcnt vmcnt(4)
    buffer_load_dwordx4 v6, s[8:11], s4 offen nt lds
    s_add_u32 m0, m0, 1024
    s_add_u32 s4, s4, s5
    buffer_load_dwordx4 v6, s[8:11], s4 offen nt lds
    s_add_u32 m0, m0, 1024
    s_add_u32 s4, s4, s5
    s_sub_u32 s64, s7, 0
    s_max_i32 s62, s64, s62
    v_mov_b32 v10, s62
    s_waitcnt vmcnt(4)
    ds_write_b32 v9, v10 offset:0
    buffer_load_dwordx4 v5, s[8:11], s4 offen nt lds
    s_add_u32 m0, m0, 1024
    s_add_u32 s4, s4, s5
    buffer_load_dwordx4 v5, s[8:11], s4 offen nt lds
    s_add_u32 m0, m0, 1024
    s_add_u32 s4, s4, s5
    s_waitcnt vmcnt(4)
    buffer_load_dwordx4 v6, s[8:11], s4 offen nt lds
    s_add_u32 m0, m0, 1024
    s_add_u32 s4, s4, s5
    buffer_load_dwordx4 v6, s[8:11], s4 offen nt lds
    s_add_u32 m0, m0, 1024
    s_add_u32 s4, s4, s5
    s_add_u32 s12, s12, 1
    s_and_b32 s12, s12, 7
    s_cselect_b32 s64, 0, s13
    s_sub_u32 s4, s4, s64
    s_add_u32 s7, s7, 1
    s_sub_u32 s6, s6, 1
    s_cmp_lg_u32 s6, 0
    s_cbranch_scc1 L_ld_11
    s_mov_b32 s6, 5
L_ld_12:
    s_waitcnt vmcnt(12)
    buffer_load_dwordx4 v5, s[8:11], s4 offen nt lds
    s_add_u32 m0, m0, 1024
    s_add_u32 s4, s4, s5
    buffer_load_dwordx4 v5, s[8:11], s4 offen nt lds
    s_add_u32 m0, m0, 1024
    s_add_u32 s4, s4, s5
    s_waitcnt vmcnt(12)
    buffer_load_dwordx4 v6, s[8:11], s4 offen nt lds
    s_add_u32 m0, m0, 1024
    s_add_u32 s4, s4, s5
    buffer_load_dwordx4 v6, s[8:11], s4 offen nt lds
    s_add_u32 m0, m0, 1024
    s_add_u32 s4, s4, s5
    s_sub_u32 s64, s7, 1
    s_max_i32 s62, s64, s62
    v_mov_b32 v10, s62
    s_waitcnt vmcnt(12)
    ds_write_b32 v9, v10 offset:0
    buffer_load_dwordx4 v5, s[8:11], s4 offen nt lds
    s_add_u32 m0, m0, 1024
    s_add_u32 s4, s4, s5
    buffer_load_dwordx4 v5, s[8:11], s4 offen nt lds
    s_add_u32 m0, m0, 1024
    s_add_u32 s4, s4, s5
    s_waitcnt vmcnt(12)
    buffer_load_dwordx4 v6, s[8:11], s4 offen nt lds
    s_add_u32 m0, m0, 1024
    s_add_u32 s4, s4, s5
    buffer_load_dwordx4 v6, s[8:11], s4 offen nt lds
    s_add_u32 m0, m0, 1024
    s_add_u32 s4, s4, s5
    s_add_u32 s12, s12, 1
    s_and_b32 s12, s12, 7
    s_cselect_b32 s64, 0, s13
    s_sub_u32 s4, s4, s64
    s_add_u32 s7, s7, 1
    s_sub_u32 s6, s6, 1
    s_cmp_lg_u32 s6, 0
    s_cbranch_scc1 L_ld_12
    s_sub_u32 s64, s7, 2
    s_max_i32 s62, s64, s62
    v_mov_b32 v10, s62
    s_waitcnt vmcnt(16)
    ds_write_b32 v9, v10 offset:0
    s_sub_u32 s64, s7, 1
    s_max_i32 s62, s64, s62
    v_mov_b32 v10, s62
    s_waitcnt vmcnt(8)
    ds_write_b32 v9, v10 offset:0
    s_sub_u32 s64, s7, 0
    s_max_i32 s62, s64, s62
    v_mov_b32 v10, s62
    s_waitcnt vmcnt(0)
    ds_write_b32 v9, v10 offset:0
    s_branch L_ld_end
L_ld_M:
    s_sub_u32 s64, s7, 3
    s_max_i32 s62, s64, s62
    v_mov_b32 v10, s62
    s_waitcnt vmcnt(24)
    ds_write_b32 v9, v10 offset:0
    buffer_load_dwordx4 v5, s[8:11], s4 offen nt lds
    s_add_u32 m0, m0, 1024
    s_add_u32 s4, s4, s5
    buffer_load_dwordx4 v5, s[8:11], s4 offen nt lds
    s_add_u32 m0, m0, 1024
    s_add_u32 s4, s4, s5
    s_waitcnt vmcnt(24)
    buffer_load_dwordx4 v6, s[8:11], s4 offen nt lds
    s_add_u32 m0, m0, 1024
    s_add_u32 s4, s4, s5
    buffer_load_dwordx4 v6, s[8:11], s4 offen nt lds
    s_add_u32 m0, m0, 1024
    s_add_u32 s4, s4, s5
    s_cmp_eq_u32 m0, 131072
    s_cselect_b32 m0, 98304, m0
    s_cselect_b32 s4, s14, s4
    s_waitcnt vmcnt(24)
    buffer_load_dwordx4 v5, s[8:11], s4 offen nt lds
    s_add_u32 m0, m0, 1024
    s_add_u32 s4, s4, s5
    buffer_load_dwordx4 v5, s[8:11], s4 offen nt lds
    s_add_u32 m0, m0, 1024
    s_add_u32 s4, s4, s5
    s_waitcnt vmcnt(24)
    buffer_load_dwordx4 v6, s[8:11], s4 offen nt lds
    s_add_u32 m0, m0, 1024
    s_add_u32 s4, s4, s5
    buffer_load_dwordx4 v6, s[8:11], s4 offen nt lds
    s_add_u32 m0, m0, 1024
    s_add_u32 s4, s4, s5
    s_cmp_eq_u32 m0, 131072
    s_cselect_b32 m0, 98304, m0
    s_cselect_b32 s4, s14, s4
    s_add_u32 s7, s7, 1
    s_mov_b32 s5, 1024
    v_lshl_add_u32 v5, v2, 8, v3
    v_lshl_add_u32 v6, v2, 8, v4
    s_mov_b32 s13, 65536
    s_lshl2_add_u32 s64, s51, s47
    s_mul_i32 s15, s64, 9
    s_mul_i32 s65, s48, 21
    s_add_u32 s15, s15, s65
    s_lshl_b32 s14, s64, 20
    s_lshl_b32 s65, s48, 10
    s_add_u32 s14, s14, s65
    s_add_u32 s14, s14, 786432
    s_bfe_u32 s65, s15, 65536
    s_lshl_b32 s65, s65, 15
    s_add_u32 s14, s14, s65
    s_bfe_u32 s65, s15, 65537
    s_lshl_b32 s65, s65, 16
    s_add_u32 s14, s14, s65
    s_bfe_u32 s65, s15, 65538
    s_lshl_b32 s65, s65, 17
    s_add_u32 s14, s14, s65
    s_bfe_u32 s65, s15, 196611
    s_lshl_b32 s65, s65, 12
    s_add_u32 s14, s14, s65
    s_mov_b32 s12, 0
    s_mov_b64 s[8:9], s[18:19]
    s_mov_b32 s10, 33554432
    s_mov_b32 m0, 0
    s_mov_b32 s6, 8
L_ld_14:
    s_sub_u32 s64, s7, 3
    s_max_i32 s62, s64, s62
    v_mov_b32 v10, s62
    s_waitcnt vmcnt(24)
    ds_write_b32 v9, v10 offset:0
    s_xor_b32 s13, s14, s12
    s_xor_b32 s4, s13, 0
    buffer_load_dwordx4 v5, s[8:11], s4 offen nt lds
    s_add_u32 m0, m0, 1024
    s_xor_b32 s4, s13, 32768
    buffer_load_dwordx4 v5, s[8:11], s4 offen nt lds
    s_add_u32 m0, m0, 1024
    s_waitcnt vmcnt(24)
    s_xor_b32 s4, s13, 65536
    buffer_load_dwordx4 v6, s[8:11], s4 offen nt lds
    s_add_u32 m0, m0, 1024
    s_xor_b32 s4, s13, 98304
    buffer_load_dwordx4 v6, s[8:11], s4 offen nt lds
    s_add_u32 m0, m0, 1024
    s_waitcnt vmcnt(24)
    s_xor_b32 s4, s13, 131072
    buffer_load_dwordx4 v5, s[8:11], s4 offen nt lds
    s_add_u32 m0, m0, 1024
    s_xor_b32 s4, s13, 163840
    buffer_load_dwordx4 v5, s[8:11], s4 offen nt lds
    s_add_u32 m0, m0, 1024
    s_waitcnt vmcnt(24)
    s_xor_b32 s4, s13, 196608
    buffer_load_dwordx4 v6, s[8:11], s4 offen nt lds
    s_add_u32 m0, m0, 1024
    s_xor_b32 s4, s13, 229376
    buffer_load_dwordx4 v6, s[8:11], s4 offen nt lds
    s_add_u32 m0, m0, 1024
    s_add_u32 s12, s12, 4096
    s_add_u32 s7, s7, 1
    s_sub_u32 s6, s6, 1
    s_cmp_lg_u32 s6, 0
    s_cbranch_scc1 L_ld_14
L_w_15:
    ds_read_b32 v11, v9 offset:44
    s_waitcnt lgkmcnt(0)
    v_readfirstlane_b32 s64, v11
    s_cmp_ge_u32 s64, 8
    s_cbranch_scc0 L_w_15
    s_mov_b64 s[8:9], s[20:21]
    s_mov_b32 s12, 0
    s_mov_b32 m0, 65536
    s_mov_b32 s6, 8
L_ld_16:
    s_sub_u32 s64, s7, 3
    s_max_i32 s62, s64, s62
    v_mov_b32 v10, s62
    s_waitcnt vmcnt(24)
    ds_write_b32 v9, v10 offset:0
    s_xor_b32 s13, s14, s12
    s_xor_b32 s4, s13, 0
    buffer_load_dwordx4 v5, s[8:11], s4 offen nt lds
    s_add_u32 m0, m0, 1024
    s_xor_b32 s4, s13, 32768
    buffer_load_dwordx4 v5, s[8:11], s4 offen nt lds
    s_add_u32 m0, m0, 1024
    s_waitcnt vmcnt(24)
    s_xor_b32 s4, s13, 65536
    buffer_load_dwordx4 v6, s[8:11], s4 offen nt lds
    s_add_u32 m0, m0, 1024
    s_xor_b32 s4, s13, 98304
    buffer_load_dwordx4 v6, s[8:11], s4 offen nt lds
    s_add_u32 m0, m0, 1024
    s_waitcnt vmcnt(24)
    s_xor_b32 s4, s13, 131072
    buffer_load_dwordx4 v5, s[8:11], s4 offen nt lds
    s_add_u32 m0, m0, 1024
    s_xor_b32 s4, s13, 163840
    buffer_load_dwordx4 v5, s[8:11], s4 offen nt lds
    s_add_u32 m0, m0, 1024
    s_waitcnt vmcnt(24)
    s_xor_b32 s4, s13, 196608
    buffer_load_dwordx4 v6, s[8:11], s4 offen nt lds
    s_add_u32 m0, m0, 1024
    s_xor_b32 s4, s13, 229376
    buffer_load_dwordx4 v6, s[8:11], s4 offen nt lds
    s_add_u32 m0, m0, 1024
    s_add_u32 s12, s12, 4096
    s_add_u32 s7, s7, 1
    s_sub_u32 s6, s6, 1
    s_cmp_lg_u32 s6, 0
    s_cbranch_scc1 L_ld_16
L_w_17:
    ds_read_b32 v11, v9 offset:48
    s_waitcnt lgkmcnt(0)
    v_readfirstlane_b32 s64, v11
    s_cmp_ge_u32 s64, 8
    s_cbranch_scc0 L_w_17
    s_mov_b32 s5, 8192
    v_lshl_add_u32 v5, v2, 11, v3
    v_lshl_add_u32 v6, v2, 11, v4
    s_mov_b32 s13, 524288
    s_mov_b64 s[8:9], s[32:33]
    s_mov_b32 s10, 7340032
    s_mov_b32 s12, s53
    s_add_u32 s4, s101, s53
    s_lshl_b32 s4, s4, 16
    s_lshl_b32 s64, s50, 8
    s_add_u32 s4, s4, s64
    s_mov_b32 m0, 0
    s_mov_b32 s6, 7
L_ld_18:
    s_waitcnt vmcnt(20)
    buffer_load_dwordx4 v5, s[8:11], s4 offen nt lds
    s_add_u32 m0, m0, 1024
    s_add_u32 s4, s4, s5
    buffer_load_dwordx4 v5, s[8:11], s4 offen nt lds
    s_add_u32 m0, m0, 1024
    s_add_u32 s4, s4, s5
    s_waitcnt vmcnt(20)
    buffer_load_dwordx4 v6, s[8:11], s4 offen nt lds
    s_add_u32 m0, m0, 1024
    s_add_u32 s4, s4, s5
    buffer_load_dwordx4 v6, s[8:11], s4 offen nt lds
    s_add_u32 m0, m0, 1024
    s_add_u32 s4, s4, s5
    s_sub_u32 s64, s7, 2
    s_max_i32 s62, s64, s62
    v_mov_b32 v10, s62
    s_waitcnt vmcnt(20)
    ds_write_b32 v9, v10 offset:0
    buffer_load_dwordx4 v5, s[8:11], s4 offen nt lds
    s_add_u32 m0, m0, 1024
    s_add_u32 s4, s4, s5
    buffer_load_dwordx4 v5, s[8:11], s4 offen nt lds
    s_add_u32 m0, m0, 1024
    s_add_u32 s4, s4, s5
    s_waitcnt vmcnt(20)
    buffer_load_dwordx4 v6, s[8:11], s4 offen nt lds
    s_add_u32 m0, m0, 1024
    s_add_u32 s4, s4, s5
    buffer_load_dwordx4 v6, s[8:11], s4 offen nt lds
    s_add_u32 m0, m0, 1024
    s_add_u32 s4, s4, s5
    s_add_u32 s12, s12, 1
    s_cmp_eq_u32 s12, 7
    s_cselect_b32 s64, 458752, 0
    s_sub_u32 s4, s4, s64
    s_add_u32 s7, s7, 1
    s_sub_u32 s6, s6, 1
    s_cmp_lg_u32 s6, 0
    s_cbranch_scc1 L_ld_18
    s_sub_u32 s64, s7, 3
    s_max_i32 s62, s64, s62
    v_mov_b32 v10, s62
    s_waitcnt vmcnt(24)
    ds_write_b32 v9, v10 offset:0
    s_sub_u32 s64, s7, 2
    s_max_i32 s62, s64, s62
    v_mov_b32 v10, s62
    s_waitcnt vmcnt(16)
    ds_write_b32 v9, v10 offset:0
    s_sub_u32 s64, s7, 1
    s_max_i32 s62, s64, s62
    v_mov_b32 v10, s62
    s_waitcnt vmcnt(8)
    ds_write_b32 v9, v10 offset:0
    s_sub_u32 s64, s7, 0
    s_max_i32 s62, s64, s62
    v_mov_b32 v10, s62
    s_waitcnt vmcnt(0)
    ds_write_b32 v9, v10 offset:0
    s_branch L_ld_end
L_ld_end:
    s_barrier
L_ld_fin:
    s_branch L_exit
L_cons:
    s_waitcnt lgkmcnt(0)
    s_load_dword s54, s[40:41], 0
    s_mul_i32 s46, s42, 14
    s_add_u32 s46, s46, s43
    s_mov_b32 s62, 0
    s_cmp_ge_u32 s43, 16
    s_cbranch_scc1 L_d2m_20
    s_cmp_ge_u32 s43, 14
    s_cselect_b32 s44, 2, 1
    s_sub_u32 s64, s42, 3
    s_cmp_lt_u32 s64, 2
    s_cselect_b32 s64, 2, 0
    s_sub_u32 s64, s43, s64
    s_bfe_u32 s50, s64, 0x10001
    s_lshl1_add_u32 s49, s42, s50
    s_and_b32 s50, s64, 1
    s_add_u32 s64, s64, 8
    s_bfe_u32 s64, s64, 0x20002
    s_lshl2_add_u32 s50, s50, s64
    s_lshl_b32 s101, s49, 3
    s_add_u32 s53, s43, s42
    s_and_b32 s53, s53, 7
    s_branch L_d2_19
L_d2m_20:
    s_mov_b32 s44, 0
    s_and_b32 s64, s42, 1
    s_bfe_u32 s51, s43, 0x20002
    s_lshl2_add_u32 s51, s64, s51
    s_and_b32 s48, s43, 3
    s_bfe_u32 s64, s43, 0x10003
    s_lshl1_add_u32 s49, s42, s64
    s_mul_i32 s101, s49, 7
    s_and_b32 s53, s43, 7
    s_cmp_eq_u32 s53, 7
    s_cselect_b32 s53, 3, s53
    s_add_u32 s50, s43, 1
    s_and_b32 s50, s50, 7
L_d2_19:
    v_mov_b32 v9, 147456
    s_cmp_eq_u32 s3, 10
    s_cbranch_scc1 L_notif
    s_sub_u32 s63, s3, 1
    s_mov_b32 s60, 0x00030003
    s_mov_b32 s61, 0xfffcfffc
    s_mov_b32 s57, 0xd800000
    v_mov_b32 v49, 0
    v_lshlrev_b32 v125, 3, v0
    v_mov_b32 v9, 147456
    v_mov_b32 v120, 1
    v_lshlrev_b32 v1, 4, v0
    v_mul_u32_u24 v122, 640, v0
    v_lshrrev_b32 v7, 4, v0
    v_bfe_u32 v8, v0, 2, 2
    v_lshl_add_u32 v2, v7, 3, v8
    v_lshlrev_b32 v2, 8, v2
    v_and_b32 v3, 1, v7
    v_lshl_or_b32 v8, v3, 2, v8
    v_xor_b32 v8, s63, v8
    v_lshl_or_b32 v2, v8, 5, v2
    v_and_b32 v8, 3, v0
    v_lshl_or_b32 v2, v8, 3, v2
    v_and_b32 v8, 7, v0
    v_lshl_add_u32 v3, v7, 3, v8
    v_lshlrev_b32 v3, 4, v3
    v_lshrrev_b32 v121, 5, v0
    v_lshlrev_b32 v121, 8, v121
    v_and_b32 v7, 2, v0
    v_lshl_or_b32 v121, v7, 6, v121
    v_and_b32 v7, 28, v0
    v_lshl_or_b32 v121, v7, 2, v121
    v_and_b32 v7, 1, v0
    v_lshl_or_b32 v121, v7, 3, v121
    s_lshl_b32 s64, s63, 9
    s_add_u32 s64, s64, 143360
    v_add_u32 v121, s64, v121
    v_lshrrev_b32 v7, 3, v121
    v_and_b32 v7, 0x70, v7
    v_xor_b32 v121, v121, v7
    s_waitcnt lgkmcnt(0)
    s_add_u32 s54, s54, 0x11111111
    s_mov_b32 s55, s54
    v_mov_b32 v4, s54
    v_and_b32 v6, 7, v0
    v_lshlrev_b32 v6, 2, v6
    v_lshrrev_b32 v124, v6, v4
    v_and_b32 v124, 15, v124
    v_lshl_or_b32 v124, v124, 14, v124
    v_and_b32 v124, s60, v124
    v_lshrrev_b32 v6, 2, v0
    v_and_b32 v6, 12, v6
    v_and_b32 v7, 1, v0
    v_lshl_or_b32 v6, v7, 4, v6
    v_lshrrev_b32 v123, v6, v4
    v_and_b32 v123, 15, v123
    v_lshl_or_b32 v123, v123, 14, v123
    v_and_b32 v123, s60, v123
    s_mov_b64 exec, 1
    ds_add_u32 v9, v120 offset:52
    s_mov_b64 exec, -1
    s_cmp_eq_u32 s3, 9
    s_cbranch_scc1 L_poller
    s_cmp_ge_u32 s63, 4
    s_cbranch_scc1 L_noq
    v_and_b32 v7, 7, v0
    v_lshlrev_b32 v126, 8, v7
    v_and_b32 v7, 8, v0
    v_lshl_or_b32 v126, v7, 2, v126
    v_lshrrev_b32 v8, 4, v0
    v_lshl_or_b32 v126, v8, 3, v126
    s_lshl_b32 s64, s63, 6
    s_add_u32 s64, s64, 141312
    v_add_u32 v126, s64, v126
    v_add_u32 v15, 141312, v1
    v_and_b32 v5, 0xf0, v1
    v_lshl_or_b32 v5, v8, 16, v5
    v_lshlrev_b32 v8, 2, v8
    v_lshl_or_b32 v8, v7, 1, v8
    v_lshrrev_b32 v16, v8, v4
    v_and_b32 v16, 15, v16
    v_lshl_or_b32 v16, v16, 14, v16
    v_and_b32 v16, s60, v16
    s_mov_b32 s58, 0x43800000
    s_and_b32 s66, s45, 7
    s_lshl3_add_u32 s64, s47, s66
    s_lshl3_add_u32 s64, s64, s100
    s_lshl_b32 s64, s64, 8
    s_add_u32 s64, s64, 524288
    s_add_u32 s68, s40, s64
    s_addc_u32 s69, s41, 0
    s_mul_i32 s64, s47, 20480
    s_add_u32 s64, s64, 65536
    s_add_u32 s70, s40, s64
    s_addc_u32 s71, s41, 0
    s_lshl_b32 s64, s63, 1
    s_xor_b32 s64, s64, s63
    s_lshl_b32 s64, s64, 5
    v_xor_b32 v10, s64, v2
    v_add_u32 v10, 98304, v10
    v_xor_b32 v12, 32, v10
    v_add_u32 v11, 131072, v3
    v_cmp_eq_u32 s[4:5], 0, v7
L_w_21:
    s_sleep 1
    ds_read_b32 v6, v9 offset:52
    s_waitcnt lgkmcnt(0)
    v_readfirstlane_b32 s64, v6
    s_cmp_ge_u32 s64, 9
    s_cbranch_scc0 L_w_21
    s_cmp_ge_u32 s62, 4
    s_cbranch_scc1 L_wpd_23
L_wp_22:
    s_sleep 1
    ds_read_b32 v6, v9 offset:0
    s_waitcnt lgkmcnt(0)
    v_readfirstlane_b32 s62, v6
    s_cmp_ge_u32 s62, 4
    s_cbranch_scc0 L_wp_22
L_wpd_23:
    ds_read_b128 v[84:87], v11 offset:0
    ds_read_b128 v[88:91], v11 offset:512
    ds_read_b128 v[92:95], v11 offset:1024
    ds_read_b128 v[96:99], v11 offset:1536
    ds_read_b64_tr_b16 v[52:53], v10 offset:0
    ds_read_b64_tr_b16 v[54:55], v10 offset:1024
    ds_read_b64_tr_b16 v[56:57], v10 offset:8192
    ds_read_b64_tr_b16 v[58:59], v10 offset:9216
    ds_read_b64_tr_b16 v[60:61], v10 offset:16384
    ds_read_b64_tr_b16 v[62:63], v10 offset:17408
    ds_read_b64_tr_b16 v[64:65], v10 offset:24576
    ds_read_b64_tr_b16 v[66:67], v10 offset:25600
    s_waitcnt lgkmcnt(6)
    ds_read_b64_tr_b16 v[68:69], v12 offset:0
    ds_read_b64_tr_b16 v[70:71], v12 offset:1024
    v_mfma_f32_16x16x32_bf16 v[20:23], v[52:55], v[84:87], 0
    s_waitcnt lgkmcnt(6)
    ds_read_b64_tr_b16 v[72:73], v12 offset:8192
    ds_read_b64_tr_b16 v[74:75], v12 offset:9216
    v_mfma_f32_16x16x32_bf16 v[20:23], v[56:59], v[88:91], v[20:23]
    s_waitcnt lgkmcnt(6)
    ds_read_b64_tr_b16 v[76:77], v12 offset:16384
    ds_read_b64_tr_b16 v[78:79], v12 offset:17408
    v_mfma_f32_16x16x32_bf16 v[20:23], v[60:63], v[92:95], v[20:23]
    s_waitcnt lgkmcnt(6)
    ds_read_b64_tr_b16 v[80:81], v12 offset:24576
    ds_read_b64_tr_b16 v[82:83], v12 offset:25600
    v_mfma_f32_16x16x32_bf16 v[20:23], v[64:67], v[96:99], v[20:23]
    s_mov_b64 exec, 3
    ds_add_u32 v9, v120 offset:44
    s_mov_b64 exec, -1
    s_waitcnt lgkmcnt(7)
    v_mfma_f32_16x16x32_bf16 v[24:27], v[68:71], v[84:87], 0
    s_waitcnt lgkmcnt(5)
    v_mfma_f32_16x16x32_bf16 v[24:27], v[72:75], v[88:91], v[24:27]
    s_waitcnt lgkmcnt(3)
    v_mfma_f32_16x16x32_bf16 v[24:27], v[76:79], v[92:95], v[24:27]
    s_waitcnt lgkmcnt(1)
    v_mfma_f32_16x16x32_bf16 v[24:27], v[80:83], v[96:99], v[24:27]
    s_nop 7
    v_cndmask_b32 v20, v24, v20, s[4:5]
    v_cndmask_b32 v21, v25, v21, s[4:5]
    v_cndmask_b32 v22, v26, v22, s[4:5]
    v_cndmask_b32 v23, v27, v23, s[4:5]
    v_pk_mul_f32 v[20:21], v[20:21], s[58:59] op_sel_hi:[1,0]
    v_pk_mul_f32 v[22:23], v[22:23], s[58:59] op_sel_hi:[1,0]
    v_max3_f32 v6, |v20|, |v21|, |v22|
    v_max_f32 v6, |v23|, v6
    v_subrev_u32 v7, 0x39800000, v6
    v_cmp_le_u32 vcc, s57, v7
L_er_25:
    v_cvt_pkrtz_f16_f32 v50, v20, v21
    v_cvt_pkrtz_f16_f32 v51, v22, v23
    v_add_u32 v50, 0x00020002, v50
    v_add_u32 v51, 0x00020002, v51
    v_and_or_b32 v50, v50, s61, v49
    v_and_or_b32 v51, v51, s61, v16
    s_cbranch_vccz L_en_24
    s_call_b64 s[6:7], L_encs
    s_branch L_er_25
L_en_24:
    ds_write_b64 v126, v[50:51]
    s_mov_b64 exec, 1
    ds_add_rtn_u32 v6, v9, v120 offset:36
    s_mov_b64 exec, -1
    ds_read_b128 v[28:31], v15
    ds_read_b128 v[32:35], v15 offset:1024
    v_add_u32 v7, 262144, v5
    s_waitcnt lgkmcnt(2)
    v_readfirstlane_b32 s64, v6
    s_cmp_lg_u32 s64, 3
    s_cbranch_scc1 L_sg_26
    s_waitcnt lgkmcnt(0)
    global_store_dwordx4 v5, v[28:31], s[68:69] sc1
    global_store_dwordx4 v7, v[32:35], s[68:69] sc1
    s_mov_b64 exec, -1
    s_nop 0
L_sg_26:
    s_waitcnt lgkmcnt(0)
    v_mov_b32 v49, 0
L_noq:
    s_cmp_ge_u32 s43, 16
    s_cbranch_scc1 L_roleM
    s_cmp_eq_u32 s44, 2
    s_cbranch_scc1 L_gate
    v_and_b32 v7, 15, v0
    v_lshrrev_b32 v8, 4, v0
    v_lshlrev_b32 v8, 3, v8
    v_lshl_or_b32 v5, v7, 5, v8
    s_mov_b32 s58, 0x44800000
    s_and_b32 s64, s46, -4
    s_lshr_b32 s65, s63, 1
    s_add_u32 s64, s64, s65
    s_and_b32 s65, s46, 3
    s_lshl2_add_u32 s64, s64, s65
    s_and_b32 s65, s63, 1
    s_lshl1_add_u32 s64, s64, s65
    s_lshl_b32 s64, s64, 8
    s_add_u32 s64, s64, 1835008
    s_add_u32 s68, s40, s64
    s_addc_u32 s69, s41, 0
    v_mov_b32 v20, 0
    v_mov_b32 v21, 0
    v_mov_b32 v22, 0
    v_mov_b32 v23, 0
    v_mov_b32 v10, v2
    v_add_u32 v11, 133120, v3
    s_mov_b32 s67, 5
    s_cmp_ge_u32 s62, 11
    s_cbranch_scc1 L_wpd_28
L_wp_27:
    s_sleep 1
    ds_read_b32 v6, v9 offset:0
    s_waitcnt lgkmcnt(0)
    v_readfirstlane_b32 s62, v6
    s_cmp_ge_u32 s62, 11
    s_cbranch_scc0 L_wp_27
L_wpd_28:
L_eg_loopG1:
    ds_read_b128 v[16:19], v11
    s_cmp_ge_u32 s62, s67
    s_cbranch_scc1 L_wpd_30
L_wp_29:
    ds_read_b32 v6, v9 offset:0
    s_waitcnt lgkmcnt(0)
    v_readfirstlane_b32 s62, v6
    s_cmp_ge_u32 s62, s67
    s_cbranch_scc0 L_wp_29
L_wpd_30:
    ds_read_b64_tr_b16 v[12:13], v10
    ds_read_b64_tr_b16 v[14:15], v10 offset:1024
    v_add_u32 v10, 8192, v10
    v_add_u32 v11, 512, v11
    s_add_u32 s67, s67, 1
    s_cmp_le_u32 s67, 12
    s_waitcnt lgkmcnt(0)
    v_mfma_f32_16x16x32_bf16 v[20:23], v[12:15], v[16:19], v[20:23]
    s_cbranch_scc1 L_eg_loopG1
    s_mov_b64 exec, 1
    ds_add_u32 v9, v120 offset:48
    s_mov_b64 exec, -1
L_eg_loopG2:
    ds_read_b128 v[16:19], v11
    s_cmp_ge_u32 s62, s67
    s_cbranch_scc1 L_wpd_32
L_wp_31:
    ds_read_b32 v6, v9 offset:0
    s_waitcnt lgkmcnt(0)
    v_readfirstlane_b32 s62, v6
    s_cmp_ge_u32 s62, s67
    s_cbranch_scc0 L_wp_31
L_wpd_32:
    ds_read_b64_tr_b16 v[12:13], v10
    ds_read_b64_tr_b16 v[14:15], v10 offset:1024
    v_add_u32 v10, 8192, v10
    v_add_u32 v11, 512, v11
    s_add_u32 s67, s67, 1
    s_cmp_le_u32 s67, 20
    s_waitcnt lgkmcnt(0)
    v_mfma_f32_16x16x32_bf16 v[20:23], v[12:15], v[16:19], v[20:23]
    s_cbranch_scc1 L_eg_loopG2
    s_nop 7
    v_pk_mul_f32 v[20:21], v[20:21], s[58:59] op_sel_hi:[1,0]
    v_pk_mul_f32 v[22:23], v[22:23], s[58:59] op_sel_hi:[1,0]
    v_max3_f32 v6, |v20|, |v21|, |v22|
    v_max_f32 v6, |v23|, v6
    v_subrev_u32 v7, 0x39800000, v6
    v_cmp_le_u32 vcc, s57, v7
L_er_34:
    v_cvt_pkrtz_f16_f32 v50, v20, v21
    v_cvt_pkrtz_f16_f32 v51, v22, v23
    v_add_u32 v50, 0x00020002, v50
    v_add_u32 v51, 0x00020002, v51
    v_and_or_b32 v50, v50, s61, v49
    v_and_or_b32 v51, v51, s61, v123
    s_cbranch_vccz L_en_33
    s_call_b64 s[6:7], L_encs
    s_branch L_er_34
L_en_33:
    s_mov_b32 exec_lo, 0x00ff00ff
    s_mov_b32 exec_hi, 0x00ff00ff
    global_store_dwordx2 v5, v[50:51], s[68:69] sc1
    s_mov_b64 exec, -1
L_bc_late:
    v_add_u32 v10, 0, v2
    v_add_u32 v11, 143360, v3
    v_lshrrev_b32 v7, 3, v11
    v_and_b32 v7, 0x70, v7
    v_xor_b32 v11, v11, v7
    v_xor_b32 v12, 64, v11
    v_and_b32 v7, 4, v0
    v_lshlrev_b32 v5, 10, v7
    v_and_b32 v7, 3, v0
    v_lshl_or_b32 v5, v7, 5, v5
    v_lshrrev_b32 v7, 4, v0
    v_lshl_or_b32 v5, v7, 3, v5
    s_lshl3_add_u32 s64, s50, s63
    s_lshl_b32 s64, s64, 6
    s_add_u32 s64, s64, s49
    s_lshl_b32 s64, s64, 7
    s_add_u32 s64, s64, 1048576
    s_add_u32 s12, s40, s64
    s_addc_u32 s13, s41, 0
    s_mov_b32 s14, 28
    s_mov_b32 s58, 0x49800000
    v_mov_b32 v49, 0
    s_mov_b32 s52, 21
    s_add_u32 s64, s101, s63
    s_lshl_b32 s64, s64, 11
    s_add_u32 s64, s64, 1572864
    s_add_u32 s68, s40, s64
    s_addc_u32 s69, s41, 0
    s_lshl_b32 s65, s63, 4
    v_and_b32 v8, 32, v0
    v_lshlrev_b32 v8, 2, v8
    v_add3_u32 v8, v8, s65, v9
    s_lshl_b32 s66, s53, 3
    v_subrev_u32 v121, s66, v0
    v_and_b32 v121, 62, v121
    v_lshlrev_b32 v121, 6, v121
    v_and_b32 v7, 1, v0
    v_lshl_or_b32 v121, v7, 3, v121
    s_add_u32 s65, s65, 143360
    v_add_u32 v121, s65, v121
    v_lshrrev_b32 v7, 3, v121
    v_and_b32 v7, 0x70, v7
    v_xor_b32 v121, v121, v7
L_lw_35:
    ds_read_b64 v[6:7], v9 offset:0
    s_waitcnt lgkmcnt(0)
    v_readfirstlane_b32 s64, v7
    v_readfirstlane_b32 s62, v6
    s_cmp_lg_u32 s64, 0
    s_cbranch_scc1 L_lwd_36
    s_cmp_lt_u32 s62, s52
    s_cbranch_scc1 L_wc_37
    s_call_b64 s[6:7], L_wcatch
L_wc_37:
    s_branch L_lw_35
L_lwd_36:
    global_load_dwordx2 v[28:29], v125, s[68:69] offset:0 sc1
    global_load_dwordx2 v[30:31], v125, s[68:69] offset:512 sc1
    global_load_dwordx2 v[32:33], v125, s[68:69] offset:1024 sc1
    global_load_dwordx2 v[34:35], v125, s[68:69] offset:1536 sc1
    s_add_u32 s65, s62, 1
    s_min_u32 s65, s65, s14
    s_cmp_lt_u32 s62, s52
    s_cbranch_scc1 L_wc_42
    s_call_b64 s[6:7], L_wcatch
L_wc_42:
    s_cmp_ge_u32 s62, s65
    s_cbranch_scc1 L_wpd_44
L_wp_43:
    ds_read_b32 v6, v9 offset:0
    s_waitcnt lgkmcnt(0)
    v_readfirstlane_b32 s62, v6
    s_cmp_ge_u32 s62, s65
    s_cbranch_scc0 L_wp_43
L_wpd_44:
    s_cmp_lt_u32 s62, s52
    s_cbranch_scc1 L_wc_45
    s_call_b64 s[6:7], L_wcatch
L_wc_45:
    s_mov_b32 s56, s60
    s_mov_b32 s67, 0
    s_branch L_gac_40
L_ga_38:
    global_load_dwordx2 v[28:29], v125, s[68:69] offset:0 sc1
    global_load_dwordx2 v[30:31], v125, s[68:69] offset:512 sc1
    global_load_dwordx2 v[32:33], v125, s[68:69] offset:1024 sc1
    global_load_dwordx2 v[34:35], v125, s[68:69] offset:1536 sc1
L_gac_40:
    s_add_u32 s67, s67, 1
    s_waitcnt vmcnt(3)
    v_xor_b32 v29, v124, v29
    s_waitcnt vmcnt(2)
    v_xor_b32 v31, v124, v31
    s_waitcnt vmcnt(1)
    v_xor_b32 v33, v124, v33
    v_or3_b32 v6, v28, v30, v32
    v_or3_b32 v7, v29, v31, v33
    s_waitcnt vmcnt(0)
    v_xor_b32 v35, v124, v35
    v_or_b32 v6, v6, v34
    v_bitop3_b32 v7, v7, v35, s60 bitop3:0xa8
    v_and_or_b32 v6, v6, s56, v7
    v_cmp_ne_u32 vcc, 0, v6
    s_cbranch_vccz L_gad_39
    v_cmp_ne_u32 vcc, 0, v7
    s_cbranch_vccnz L_gar_41
    s_mov_b32 s56, 0
    s_branch L_gad_39
L_gar_41:
    s_cmp_le_u32 s67, 100000
    s_cbranch_scc1 L_ga_38
L_gad_39:
L_cw_46:
    ds_read_b32 v6, v9 offset:12
    ds_read_b128 v[44:47], v8 offset:128
    s_waitcnt lgkmcnt(0)
    v_readfirstlane_b32 s64, v6
    s_cmp_ge_u32 s64, 1
    s_cbranch_scc0 L_cw_46
    s_cmp_lg_u32 s56, 0
    s_cbranch_scc1 L_onofix
    s_call_b64 s[6:7], L_fix
L_onofix:
    v_fma_mix_f32 v40, v28, v44, 0 op_sel:[0,0,0] op_sel_hi:[1,0,0]
    v_fma_mix_f32 v41, v28, v44, 0 op_sel:[1,0,0] op_sel_hi:[1,0,0]
    v_fma_mix_f32 v42, v29, v44, 0 op_sel:[0,0,0] op_sel_hi:[1,0,0]
    v_fma_mix_f32 v43, v29, v44, 0 op_sel:[1,0,0] op_sel_hi:[1,0,0]
    v_fma_mix_f32 v40, v30, v45, v40 op_sel:[0,0,0] op_sel_hi:[1,0,0]
    v_fma_mix_f32 v41, v30, v45, v41 op_sel:[1,0,0] op_sel_hi:[1,0,0]
    v_fma_mix_f32 v42, v31, v45, v42 op_sel:[0,0,0] op_sel_hi:[1,0,0]
    v_fma_mix_f32 v43, v31, v45, v43 op_sel:[1,0,0] op_sel_hi:[1,0,0]
    v_fma_mix_f32 v40, v32, v46, v40 op_sel:[0,0,0] op_sel_hi:[1,0,0]
    v_fma_mix_f32 v41, v32, v46, v41 op_sel:[1,0,0] op_sel_hi:[1,0,0]
    v_fma_mix_f32 v42, v33, v46, v42 op_sel:[0,0,0] op_sel_hi:[1,0,0]
    v_fma_mix_f32 v43, v33, v46, v43 op_sel:[1,0,0] op_sel_hi:[1,0,0]
    v_fma_mix_f32 v40, v34, v47, v40 op_sel:[0,0,0] op_sel_hi:[1,0,0]
    v_fma_mix_f32 v41, v34, v47, v41 op_sel:[1,0,0] op_sel_hi:[1,0,0]
    v_fma_mix_f32 v42, v35, v47, v42 op_sel:[0,0,0] op_sel_hi:[1,0,0]
    v_fma_mix_f32 v43, v35, v47, v43 op_sel:[1,0,0] op_sel_hi:[1,0,0]
    s_branch L_late
L_roleM:
    s_lshl2_add_u32 s64, s51, s47
    s_lshl3_add_u32 s64, s64, s63
    s_lshl_b32 s64, s64, 11
    s_add_u32 s64, s64, 524288
    s_add_u32 s68, s40, s64
    s_addc_u32 s69, s41, 0
    v_bfe_u32 v7, v0, 2, 2
    v_and_b32 v8, 3, v0
    v_lshl_add_u32 v7, v7, 3, v8
    v_lshlrev_b32 v10, 8, v7
    v_lshrrev_b32 v7, 5, v0
    v_and_b32 v8, 7, v0
    v_xor_b32 v7, v7, v8
    v_lshl_or_b32 v10, v7, 5, v10
    v_and_b32 v7, 16, v0
    s_lshl_b32 s64, s63, 13
    v_add3_u32 v10, v10, v7, s64
    v_and_b32 v12, 30, v0
    v_lshlrev_b32 v12, 6, v12
    v_and_b32 v7, 1, v0
    v_lshl_or_b32 v12, v7, 3, v12
    v_lshrrev_b32 v7, 5, v0
    v_lshl_or_b32 v12, v7, 2, v12
    s_lshl_b32 s64, s63, 4
    s_add_u32 s64, s64, 133120
    v_add_u32 v12, s64, v12
    v_lshl_add_u32 v13, v8, 2, v9
    s_lshl_b32 s64, s63, 9
    s_add_u32 s64, s64, 135168
    v_add_u32 v14, s64, v3
    v_lshrrev_b32 v8, 4, v0
    v_and_b32 v7, 7, v0
    v_lshlrev_b32 v126, 8, v7
    v_lshl_or_b32 v126, v8, 3, v126
    s_lshl_b32 s64, s63, 5
    s_add_u32 s64, s64, 141312
    v_add_u32 v126, s64, v126
    v_add_u32 v15, 141312, v1
    v_and_b32 v5, 0x1f0, v1
    v_and_b32 v7, 32, v0
    v_lshl_or_b32 v5, v7, 9, v5
    s_and_b32 s64, s63, 1
    s_lshl_b32 s64, s64, 4
    v_lshl_or_b32 v8, v8, 2, s64
    v_lshrrev_b32 v117, v8, v4
    v_and_b32 v117, 15, v117
    v_lshl_or_b32 v117, v117, 14, v117
    v_and_b32 v117, s60, v117
    s_cmp_ge_u32 s62, 9
    s_cbranch_scc1 L_wpd_48
L_wp_47:
    s_sleep 1
    ds_read_b32 v6, v9 offset:0
    s_waitcnt lgkmcnt(0)
    v_readfirstlane_b32 s62, v6
    s_cmp_ge_u32 s62, 9
    s_cbranch_scc0 L_wp_47
L_wpd_48:
    v_mov_b32 v44, 0x3b800000
    v_mov_b32 v45, 0x3b800000
    v_mov_b32 v46, 0x3b800000
    v_mov_b32 v47, 0x3b800000
    global_load_dwordx2 v[28:29], v125, s[68:69] offset:0 sc1
    global_load_dwordx2 v[30:31], v125, s[68:69] offset:512 sc1
    global_load_dwordx2 v[32:33], v125, s[68:69] offset:1024 sc1
    global_load_dwordx2 v[34:35], v125, s[68:69] offset:1536 sc1
    s_add_u32 s65, s63, 5
    s_cmp_ge_u32 s62, s65
    s_cbranch_scc1 L_wpd_54
L_wp_53:
    ds_read_b32 v6, v9 offset:0
    s_waitcnt lgkmcnt(0)
    v_readfirstlane_b32 s62, v6
    s_cmp_ge_u32 s62, s65
    s_cbranch_scc0 L_wp_53
L_wpd_54:
    ds_read_b128 v[52:55], v10
    ds_read_b128 v[68:71], v10 offset:1024
    v_xor_b32 v11, 64, v10
    ds_read_b128 v[56:59], v11
    ds_read_b128 v[72:75], v11 offset:1024
    v_xor_b32 v11, 128, v10
    ds_read_b128 v[60:63], v11
    ds_read_b128 v[76:79], v11 offset:1024
    v_xor_b32 v11, 192, v10
    ds_read_b128 v[64:67], v11
    ds_read_b128 v[80:83], v11 offset:1024
    s_mov_b64 exec, 1
    ds_add_u32 v9, v120 offset:48
    s_mov_b64 exec, -1
    v_add_u32 v11, 133120, v3
    s_mov_b32 s56, s60
    s_mov_b32 s67, 0
    s_branch L_gac_51
L_ga_49:
    s_sleep 4
    global_load_dwordx2 v[28:29], v125, s[68:69] offset:0 sc1
    global_load_dwordx2 v[30:31], v125, s[68:69] offset:512 sc1
    global_load_dwordx2 v[32:33], v125, s[68:69] offset:1024 sc1
    global_load_dwordx2 v[34:35], v125, s[68:69] offset:1536 sc1
L_gac_51:
    s_add_u32 s67, s67, 1
    s_waitcnt vmcnt(3)
    v_xor_b32 v29, v124, v29
    v_fma_mix_f32 v40, v28, v44, 0 op_sel:[0,0,0] op_sel_hi:[1,0,0]
    v_fma_mix_f32 v41, v28, v44, 0 op_sel:[1,0,0] op_sel_hi:[1,0,0]
    v_fma_mix_f32 v42, v29, v44, 0 op_sel:[0,0,0] op_sel_hi:[1,0,0]
    v_fma_mix_f32 v43, v29, v44, 0 op_sel:[1,0,0] op_sel_hi:[1,0,0]
    s_waitcnt vmcnt(2)
    v_xor_b32 v31, v124, v31
    v_fma_mix_f32 v40, v30, v45, v40 op_sel:[0,0,0] op_sel_hi:[1,0,0]
    v_fma_mix_f32 v41, v30, v45, v41 op_sel:[1,0,0] op_sel_hi:[1,0,0]
    v_fma_mix_f32 v42, v31, v45, v42 op_sel:[0,0,0] op_sel_hi:[1,0,0]
    v_fma_mix_f32 v43, v31, v45, v43 op_sel:[1,0,0] op_sel_hi:[1,0,0]
    s_waitcnt vmcnt(1)
    v_xor_b32 v33, v124, v33
    v_or3_b32 v6, v28, v30, v32
    v_or3_b32 v7, v29, v31, v33
    v_fma_mix_f32 v40, v32, v46, v40 op_sel:[0,0,0] op_sel_hi:[1,0,0]
    v_fma_mix_f32 v41, v32, v46, v41 op_sel:[1,0,0] op_sel_hi:[1,0,0]
    v_fma_mix_f32 v42, v33, v46, v42 op_sel:[0,0,0] op_sel_hi:[1,0,0]
    v_fma_mix_f32 v43, v33, v46, v43 op_sel:[1,0,0] op_sel_hi:[1,0,0]
    s_waitcnt vmcnt(0)
    v_xor_b32 v35, v124, v35
    v_or_b32 v6, v6, v34
    v_bitop3_b32 v7, v7, v35, s60 bitop3:0xa8
    v_and_or_b32 v6, v6, s56, v7
    v_cmp_ne_u32 vcc, 0, v6
    v_fma_mix_f32 v40, v34, v47, v40 op_sel:[0,0,0] op_sel_hi:[1,0,0]
    v_fma_mix_f32 v41, v34, v47, v41 op_sel:[1,0,0] op_sel_hi:[1,0,0]
    v_fma_mix_f32 v42, v35, v47, v42 op_sel:[0,0,0] op_sel_hi:[1,0,0]
    v_fma_mix_f32 v43, v35, v47, v43 op_sel:[1,0,0] op_sel_hi:[1,0,0]
    s_cbranch_vccz L_gad_50
    v_cmp_ne_u32 vcc, 0, v7
    s_cbranch_vccnz L_gar_52
    s_mov_b32 s56, 0
    s_call_b64 s[6:7], L_fixr
    s_branch L_gac_51
L_gar_52:
    s_cmp_le_u32 s67, 100000
    s_cbranch_scc1 L_ga_49
L_gad_50:
    s_nop 1
    v_permlane32_swap_b32 v40, v42
    v_permlane32_swap_b32 v41, v43
    v_add_f32 v40, v40, v42
    v_add_f32 v41, v41, v43
    v_cvt_pk_bf16_f32 v28, v40, v41
    ds_write_b32 v12, v28
    s_mov_b64 exec, 1
    ds_add_u32 v9, v120 offset:16
    s_mov_b64 exec, -1
    s_lshl_b32 s64, s47, 5
    s_add_u32 s64, s64, s51
    s_lshl2_add_u32 s64, s64, s48
    s_lshl_b32 s64, s64, 9
    s_add_u32 s64, s64, 1572864
    s_add_u32 s68, s40, s64
    s_addc_u32 s69, s41, 0
    s_lshl2_add_u32 s66, s51, s48
    s_mul_i32 s64, s47, 20480
    s_add_u32 s64, s64, 163840
    s_add_u32 s70, s40, s64
    s_addc_u32 s71, s41, 0
    s_lshl_b32 s64, s47, 5
    s_add_u32 s64, s64, s66
    s_lshl_b32 s64, s64, 6
    s_add_u32 s64, s64, 16384
    s_add_u32 s12, s40, s64
    s_addc_u32 s13, s41, 0
    s_mov_b32 s65, 0x3e0293ee
L_w_55:
    ds_read_b32 v6, v9 offset:16
    s_waitcnt lgkmcnt(0)
    v_readfirstlane_b32 s64, v6
    s_cmp_ge_u32 s64, 8
    s_cbranch_scc0 L_w_55
    ds_read_b128 v[84:87], v11 offset:0
    ds_read_b128 v[88:91], v11 offset:512
    ds_read_b128 v[92:95], v11 offset:1024
    ds_read_b128 v[96:99], v11 offset:1536
    s_waitcnt lgkmcnt(3)
    v_mfma_f32_16x16x32_bf16 v[20:23], v[52:55], v[84:87], 0
    v_mfma_f32_16x16x32_bf16 v[24:27], v[68:71], v[84:87], 0
    s_waitcnt lgkmcnt(2)
    v_mfma_f32_16x16x32_bf16 v[20:23], v[56:59], v[88:91], v[20:23]
    v_mfma_f32_16x16x32_bf16 v[24:27], v[72:75], v[88:91], v[24:27]
    s_waitcnt lgkmcnt(1)
    v_mfma_f32_16x16x32_bf16 v[20:23], v[60:63], v[92:95], v[20:23]
    v_mfma_f32_16x16x32_bf16 v[24:27], v[76:79], v[92:95], v[24:27]
    s_waitcnt lgkmcnt(0)
    v_mfma_f32_16x16x32_bf16 v[20:23], v[64:67], v[96:99], v[20:23]
    v_mfma_f32_16x16x32_bf16 v[24:27], v[80:83], v[96:99], v[24:27]
    v_add_u32 v11, 135168, v3
    v_add_u32 v10, 65536, v2
    v_mov_b32 v28, 0x3f803f80
    v_mov_b32 v29, 0x3f803f80
    v_mov_b32 v30, 0x3f803f80
    v_mov_b32 v31, 0x3f803f80
    s_nop 1
    v_max3_f32 v7, v20, v21, v22
    v_max3_f32 v7, v7, v23, v24
    v_max3_f32 v7, v7, v25, v26
    v_max_f32 v7, v7, v27
    s_mov_b32 exec_lo, 0x00ff00ff
    s_mov_b32 exec_hi, 0x00ff00ff
    ds_max_f32 v13, v7 offset:64
    s_mov_b64 exec, 1
    ds_add_u32 v9, v120 offset:20
    s_mov_b64 exec, -1
L_cw_56:
    ds_read_b32 v6, v9 offset:20
    ds_read_b32 v44, v13 offset:64
    s_waitcnt lgkmcnt(1)
    v_readfirstlane_b32 s64, v6
    s_cmp_ge_u32 s64, 8
    s_cbranch_scc0 L_cw_56
    s_waitcnt lgkmcnt(0)
    s_mov_b32 s52, 0
    v_mul_f32 v44, s65, v44
    v_fma_f32 v20, v20, s65, -v44
    v_fma_f32 v21, v21, s65, -v44
    v_fma_f32 v22, v22, s65, -v44
    v_fma_f32 v23, v23, s65, -v44
    v_fma_f32 v24, v24, s65, -v44
    v_fma_f32 v25, v25, s65, -v44
    v_fma_f32 v26, v26, s65, -v44
    v_fma_f32 v27, v27, s65, -v44
    v_exp_f32 v20, v20
    v_exp_f32 v21, v21
    v_exp_f32 v22, v22
    v_exp_f32 v23, v23
    v_exp_f32 v24, v24
    v_exp_f32 v25, v25
    v_exp_f32 v26, v26
    v_exp_f32 v27, v27
    s_nop 0
    v_cvt_pk_bf16_f32 v16, v20, v21
    v_cvt_pk_bf16_f32 v17, v22, v23
    v_cvt_pk_bf16_f32 v18, v24, v25
    v_cvt_pk_bf16_f32 v19, v26, v27
    ds_write_b128 v14, v[16:19]
    s_mov_b64 exec, 1
    ds_add_u32 v9, v120 offset:24
    s_mov_b64 exec, -1
L_w_57:
    ds_read_b32 v6, v9 offset:24
    s_waitcnt lgkmcnt(0)
    v_readfirstlane_b32 s64, v6
    s_cmp_ge_u32 s64, 8
    s_cbranch_scc0 L_w_57
    ds_read_b128 v[84:87], v11 offset:0
    ds_read_b128 v[88:91], v11 offset:512
    ds_read_b128 v[92:95], v11 offset:1024
    ds_read_b128 v[96:99], v11 offset:1536
    ds_read_b128 v[100:103], v11 offset:2048
    ds_read_b128 v[104:107], v11 offset:2560
    ds_read_b128 v[108:111], v11 offset:3072
    ds_read_b128 v[112:115], v11 offset:3584
    ds_read_b32 v6, v9 offset:0
    s_waitcnt lgkmcnt(8)
    v_mfma_f32_16x16x32_bf16 v[24:27], v[28:31], v[84:87], 0
    s_waitcnt lgkmcnt(7)
    v_mfma_f32_16x16x32_bf16 v[24:27], v[28:31], v[88:91], v[24:27]
    s_waitcnt lgkmcnt(6)
    v_mfma_f32_16x16x32_bf16 v[24:27], v[28:31], v[92:95], v[24:27]
    s_waitcnt lgkmcnt(5)
    v_mfma_f32_16x16x32_bf16 v[24:27], v[28:31], v[96:99], v[24:27]
    s_waitcnt lgkmcnt(4)
    v_mfma_f32_16x16x32_bf16 v[24:27], v[28:31], v[100:103], v[24:27]
    s_waitcnt lgkmcnt(3)
    v_mfma_f32_16x16x32_bf16 v[24:27], v[28:31], v[104:107], v[24:27]
    s_waitcnt lgkmcnt(2)
    v_mfma_f32_16x16x32_bf16 v[24:27], v[28:31], v[108:111], v[24:27]
    s_waitcnt lgkmcnt(1)
    v_mfma_f32_16x16x32_bf16 v[24:27], v[28:31], v[112:115], v[24:27]
    s_waitcnt lgkmcnt(0)
    v_readfirstlane_b32 s62, v6
    s_cmp_lt_u32 s62, 20
    s_cbranch_scc1 L_pv_slow
    ds_read_b64_tr_b16 v[52:53], v10 offset:0
    ds_read_b64_tr_b16 v[54:55], v10 offset:1024
    ds_read_b64_tr_b16 v[56:57], v10 offset:8192
    ds_read_b64_tr_b16 v[58:59], v10 offset:9216
    ds_read_b64_tr_b16 v[60:61], v10 offset:16384
    ds_read_b64_tr_b16 v[62:63], v10 offset:17408
    ds_read_b64_tr_b16 v[64:65], v10 offset:24576
    ds_read_b64_tr_b16 v[66:67], v10 offset:25600
    ds_read_b64_tr_b16 v[68:69], v10 offset:32768
    ds_read_b64_tr_b16 v[70:71], v10 offset:33792
    ds_read_b64_tr_b16 v[72:73], v10 offset:40960
    ds_read_b64_tr_b16 v[74:75], v10 offset:41984
    ds_read_b64_tr_b16 v[76:77], v10 offset:49152
    ds_read_b64_tr_b16 v[78:79], v10 offset:50176
    v_log_f32 v45, v24
    v_rcp_f32 v46, v24
    s_nop 0
    v_mul_f32 v46, 0x45800000, v46
    s_cmp_lg_u32 s63, 0
    s_cbranch_scc1 L_nolse_58
    v_add_f32 v44, v44, v45
    v_mov_b32 v45, s54
    v_lshlrev_b32 v7, 3, v0
    s_mov_b64 exec, 0xff
    global_store_dwordx2 v7, v[44:45], s[12:13] sc1
    s_mov_b64 exec, -1
L_nolse_58:
    s_waitcnt lgkmcnt(12)
    ds_read_b64_tr_b16 v[80:81], v10 offset:57344
    ds_read_b64_tr_b16 v[82:83], v10 offset:58368
    v_mfma_f32_16x16x32_bf16 v[20:23], v[52:55], v[84:87], 0
    s_waitcnt lgkmcnt(12)
    v_mfma_f32_16x16x32_bf16 v[20:23], v[56:59], v[88:91], v[20:23]
    s_waitcnt lgkmcnt(10)
    v_mfma_f32_16x16x32_bf16 v[20:23], v[60:63], v[92:95], v[20:23]
    s_waitcnt lgkmcnt(8)
    v_mfma_f32_16x16x32_bf16 v[20:23], v[64:67], v[96:99], v[20:23]
    s_waitcnt lgkmcnt(6)
    v_mfma_f32_16x16x32_bf16 v[20:23], v[68:71], v[100:103], v[20:23]
    s_waitcnt lgkmcnt(4)
    v_mfma_f32_16x16x32_bf16 v[20:23], v[72:75], v[104:107], v[20:23]
    s_waitcnt lgkmcnt(2)
    v_mfma_f32_16x16x32_bf16 v[20:23], v[76:79], v[108:111], v[20:23]
    s_branch L_pv_last
L_pv_slow:
    s_nop 4
    v_log_f32 v45, v24
    v_rcp_f32 v46, v24
    s_nop 0
    v_mul_f32 v46, 0x45800000, v46
    s_cmp_lg_u32 s63, 0
    s_cbranch_scc1 L_nolse_59
    v_add_f32 v44, v44, v45
    v_mov_b32 v45, s54
    v_lshlrev_b32 v7, 3, v0
    s_mov_b64 exec, 0xff
    global_store_dwordx2 v7, v[44:45], s[12:13] sc1
    s_mov_b64 exec, -1
L_nolse_59:
    s_cmp_ge_u32 s62, 13
    s_cbranch_scc1 L_wpd_61
L_wp_60:
    ds_read_b32 v6, v9 offset:0
    s_waitcnt lgkmcnt(0)
    v_readfirstlane_b32 s62, v6
    s_cmp_ge_u32 s62, 13
    s_cbranch_scc0 L_wp_60
L_wpd_61:
    ds_read_b64_tr_b16 v[52:53], v10 offset:0
    ds_read_b64_tr_b16 v[54:55], v10 offset:1024
    s_cmp_ge_u32 s62, 14
    s_cbranch_scc1 L_wpd_63
L_wp_62:
    ds_read_b32 v6, v9 offset:0
    s_waitcnt lgkmcnt(0)
    v_readfirstlane_b32 s62, v6
    s_cmp_ge_u32 s62, 14
    s_cbranch_scc0 L_wp_62
L_wpd_63:
    ds_read_b64_tr_b16 v[56:57], v10 offset:8192
    ds_read_b64_tr_b16 v[58:59], v10 offset:9216
    s_waitcnt lgkmcnt(2)
    v_mfma_f32_16x16x32_bf16 v[20:23], v[52:55], v[84:87], 0
    s_cmp_ge_u32 s62, 15
    s_cbranch_scc1 L_wpd_65
L_wp_64:
    ds_read_b32 v6, v9 offset:0
    s_waitcnt lgkmcnt(0)
    v_readfirstlane_b32 s62, v6
    s_cmp_ge_u32 s62, 15
    s_cbranch_scc0 L_wp_64
L_wpd_65:
    ds_read_b64_tr_b16 v[60:61], v10 offset:16384
    ds_read_b64_tr_b16 v[62:63], v10 offset:17408
    s_waitcnt lgkmcnt(2)
    v_mfma_f32_16x16x32_bf16 v[20:23], v[56:59], v[88:91], v[20:23]
    s_cmp_ge_u32 s62, 16
    s_cbranch_scc1 L_wpd_67
L_wp_66:
    ds_read_b32 v6, v9 offset:0
    s_waitcnt lgkmcnt(0)
    v_readfirstlane_b32 s62, v6
    s_cmp_ge_u32 s62, 16
    s_cbranch_scc0 L_wp_66
L_wpd_67:
    ds_read_b64_tr_b16 v[64:65], v10 offset:24576
    ds_read_b64_tr_b16 v[66:67], v10 offset:25600
    s_waitcnt lgkmcnt(2)
    v_mfma_f32_16x16x32_bf16 v[20:23], v[60:63], v[92:95], v[20:23]
    s_cmp_ge_u32 s62, 17
    s_cbranch_scc1 L_wpd_69
L_wp_68:
    ds_read_b32 v6, v9 offset:0
    s_waitcnt lgkmcnt(0)
    v_readfirstlane_b32 s62, v6
    s_cmp_ge_u32 s62, 17
    s_cbranch_scc0 L_wp_68
L_wpd_69:
    ds_read_b64_tr_b16 v[68:69], v10 offset:32768
    ds_read_b64_tr_b16 v[70:71], v10 offset:33792
    s_waitcnt lgkmcnt(2)
    v_mfma_f32_16x16x32_bf16 v[20:23], v[64:67], v[96:99], v[20:23]
    s_cmp_ge_u32 s62, 18
    s_cbranch_scc1 L_wpd_71
L_wp_70:
    ds_read_b32 v6, v9 offset:0
    s_waitcnt lgkmcnt(0)
    v_readfirstlane_b32 s62, v6
    s_cmp_ge_u32 s62, 18
    s_cbranch_scc0 L_wp_70
L_wpd_71:
    ds_read_b64_tr_b16 v[72:73], v10 offset:40960
    ds_read_b64_tr_b16 v[74:75], v10 offset:41984
    s_waitcnt lgkmcnt(2)
    v_mfma_f32_16x16x32_bf16 v[20:23], v[68:71], v[100:103], v[20:23]
    s_cmp_ge_u32 s62, 19
    s_cbranch_scc1 L_wpd_73
L_wp_72:
    ds_read_b32 v6, v9 offset:0
    s_waitcnt lgkmcnt(0)
    v_readfirstlane_b32 s62, v6
    s_cmp_ge_u32 s62, 19
    s_cbranch_scc0 L_wp_72
L_wpd_73:
    ds_read_b64_tr_b16 v[76:77], v10 offset:49152
    ds_read_b64_tr_b16 v[78:79], v10 offset:50176
    s_waitcnt lgkmcnt(2)
    v_mfma_f32_16x16x32_bf16 v[20:23], v[72:75], v[104:107], v[20:23]
    s_cmp_ge_u32 s62, 20
    s_cbranch_scc1 L_wpd_75
L_wp_74:
    ds_read_b32 v6, v9 offset:0
    s_waitcnt lgkmcnt(0)
    v_readfirstlane_b32 s62, v6
    s_cmp_ge_u32 s62, 20
    s_cbranch_scc0 L_wp_74
L_wpd_75:
    ds_read_b64_tr_b16 v[80:81], v10 offset:57344
    ds_read_b64_tr_b16 v[82:83], v10 offset:58368
    s_waitcnt lgkmcnt(2)
    v_mfma_f32_16x16x32_bf16 v[20:23], v[76:79], v[108:111], v[20:23]
L_pv_last:
    s_waitcnt lgkmcnt(0)
    v_mfma_f32_16x16x32_bf16 v[20:23], v[80:83], v[112:115], v[20:23]
    s_nop 7
    v_pk_mul_f32 v[20:21], v[20:21], v[46:47] op_sel_hi:[1,0]
    v_pk_mul_f32 v[22:23], v[22:23], v[46:47] op_sel_hi:[1,0]
    v_max3_f32 v6, |v20|, |v21|, |v22|
    v_max_f32 v6, |v23|, v6
    v_subrev_u32 v7, 0x39800000, v6
    v_cmp_le_u32 vcc, s57, v7
L_er_77:
    v_cvt_pkrtz_f16_f32 v50, v20, v21
    v_cvt_pkrtz_f16_f32 v51, v22, v23
    v_add_u32 v50, 0x00020002, v50
    v_add_u32 v51, 0x00020002, v51
    v_and_or_b32 v50, v50, s61, v49
    v_and_or_b32 v51, v51, s61, v117
    s_cbranch_vccz L_en_76
    s_call_b64 s[6:7], L_encs
    s_branch L_er_77
L_en_76:
    s_mov_b32 exec_lo, 0x00ff00ff
    s_mov_b32 exec_hi, 0x00ff00ff
    ds_write_b64 v126, v[50:51]
    s_mov_b64 exec, 1
    ds_add_rtn_u32 v6, v9, v120 offset:40
    s_mov_b64 exec, -1
    ds_read_b128 v[28:31], v15
    ds_read_b128 v[32:35], v15 offset:1024
    v_add_u32 v7, 32768, v5
    s_waitcnt lgkmcnt(2)
    v_readfirstlane_b32 s64, v6
    s_cmp_lg_u32 s64, 7
    s_cbranch_scc1 L_sg_78
    s_waitcnt lgkmcnt(0)
    global_store_dwordx4 v5, v[28:31], s[68:69] sc1
    global_store_dwordx4 v7, v[32:35], s[68:69] sc1
    s_mov_b64 exec, -1
    s_nop 0
L_sg_78:
    s_waitcnt lgkmcnt(0)
    s_and_b32 s65, s43, 1
    s_lshl_b32 s65, s65, 4
    v_and_b32 v7, 12, v0
    v_add_u32 v7, v7, v9
L_cw_79:
    ds_read_b32 v6, v9 offset:8
    ds_read_b32 v116, v7 offset:96
    s_waitcnt lgkmcnt(0)
    v_readfirstlane_b32 s64, v6
    s_cmp_ge_u32 s64, 1
    s_cbranch_scc0 L_cw_79
    s_lshl4_add_u32 s64, s42, s43
    s_sub_u32 s66, s64, 16
    s_lshl3_add_u32 s64, s66, s63
    s_lshl_b32 s64, s64, 9
    s_add_u32 s64, s64, 1048576
    s_add_u32 s10, s40, s64
    s_addc_u32 s11, s41, 0
    v_lshlrev_b32 v118, 2, v0
    v_add_u32 v118, 139264, v118
    s_lshl_b32 s64, s63, 8
    v_add_u32 v117, s64, v118
    v_and_b32 v119, 12, v0
    v_lshlrev_b32 v119, 9, v119
    v_and_b32 v7, 3, v0
    v_lshl_or_b32 v119, v7, 3, v119
    v_lshrrev_b32 v7, 4, v0
    v_lshl_or_b32 v119, v7, 1, v119
    s_lshl_b32 s65, s65, 9
    s_lshr_b32 s66, s66, 1
    s_lshl_b32 s66, s66, 5
    s_add_u32 s65, s65, s66
    v_add_u32 v119, s65, v119
    s_waitcnt lgkmcnt(0)
    s_cmp_lt_u32 s63, 4
    s_cbranch_scc1 L_wg_done
    v_sub_f32 v116, 1.0, v116
    v_cvt_pk_bf16_f32 v116, v116, v116
    v_and_b32 v116, 0xffff0000, v116
L_wg_done:
    v_mul_f32 v116, 0x35800000, v116
    v_mov_b32 v44, 0x3a800000
    v_mov_b32 v45, 0x3a800000
    v_mov_b32 v46, 0x3a800000
    v_mov_b32 v47, 0x3a800000
    v_add_u32 v10, 0, v2
    v_add_u32 v11, 143360, v3
    v_lshrrev_b32 v7, 3, v11
    v_and_b32 v7, 0x70, v7
    v_xor_b32 v11, v11, v7
    v_xor_b32 v12, 64, v11
    v_and_b32 v7, 4, v0
    v_lshlrev_b32 v5, 10, v7
    v_and_b32 v7, 3, v0
    v_lshl_or_b32 v5, v7, 5, v5
    v_lshrrev_b32 v7, 4, v0
    v_lshl_or_b32 v5, v7, 3, v5
    s_lshl3_add_u32 s64, s50, s63
    s_lshl_b32 s64, s64, 6
    s_add_u32 s64, s64, s49
    s_lshl_b32 s64, s64, 7
    s_add_u32 s64, s64, 1050624
    s_add_u32 s12, s40, s64
    s_addc_u32 s13, s41, 0
    s_mov_b32 s14, 27
    s_mov_b32 s58, 0x49800000
    v_mov_b32 v49, 0
    s_mov_b32 s52, 21
    s_add_u32 s64, s101, s63
    s_lshl_b32 s64, s64, 11
    s_add_u32 s64, s63, s53
    s_cmp_ge_u32 s64, 7
    s_cselect_b32 s65, 7, 0
    s_sub_u32 s64, s64, s65
    s_add_u32 s64, s64, s101
    s_lshl_b32 s64, s64, 11
    s_add_u32 s64, s64, 1835008
    s_add_u32 s68, s40, s64
    s_addc_u32 s69, s41, 0
    v_mov_b32 v40, 0
    v_mov_b32 v41, 0
    v_mov_b32 v42, 0
    v_mov_b32 v43, 0
L_lw_80:
    ds_read_b64 v[6:7], v9 offset:0
    s_waitcnt lgkmcnt(0)
    v_readfirstlane_b32 s64, v7
    v_readfirstlane_b32 s62, v6
    s_cmp_lg_u32 s64, 0
    s_cbranch_scc1 L_lwd_81
    s_cmp_lt_u32 s62, s52
    s_cbranch_scc1 L_wc_82
    s_call_b64 s[6:7], L_wcatch
L_wc_82:
    s_branch L_lw_80
L_lwd_81:
    s_cmp_eq_u32 s63, 7
    s_cbranch_scc1 L_late
    global_load_dwordx2 v[28:29], v125, s[68:69] offset:0 sc1
    global_load_dwordx2 v[30:31], v125, s[68:69] offset:512 sc1
    global_load_dwordx2 v[32:33], v125, s[68:69] offset:1024 sc1
    global_load_dwordx2 v[34:35], v125, s[68:69] offset:1536 sc1
    s_add_u32 s65, s62, 1
    s_min_u32 s65, s65, s14
    s_cmp_lt_u32 s62, s52
    s_cbranch_scc1 L_wc_87
    s_call_b64 s[6:7], L_wcatch
L_wc_87:
    s_cmp_ge_u32 s62, s65
    s_cbranch_scc1 L_wpd_89
L_wp_88:
    ds_read_b32 v6, v9 offset:0
    s_waitcnt lgkmcnt(0)
    v_readfirstlane_b32 s62, v6
    s_cmp_ge_u32 s62, s65
    s_cbranch_scc0 L_wp_88
L_wpd_89:
    s_cmp_lt_u32 s62, s52
    s_cbranch_scc1 L_wc_90
    s_call_b64 s[6:7], L_wcatch
L_wc_90:
    s_mov_b32 s56, s60
    s_mov_b32 s67, 0
    s_branch L_gac_85
L_ga_83:
    global_load_dwordx2 v[28:29], v125, s[68:69] offset:0 sc1
    global_load_dwordx2 v[30:31], v125, s[68:69] offset:512 sc1
    global_load_dwordx2 v[32:33], v125, s[68:69] offset:1024 sc1
    global_load_dwordx2 v[34:35], v125, s[68:69] offset:1536 sc1
L_gac_85:
    s_add_u32 s67, s67, 1
    s_waitcnt vmcnt(3)
    v_xor_b32 v29, v124, v29
    v_fma_mix_f32 v40, v28, v44, 0 op_sel:[0,0,0] op_sel_hi:[1,0,0]
    v_fma_mix_f32 v41, v28, v44, 0 op_sel:[1,0,0] op_sel_hi:[1,0,0]
    v_fma_mix_f32 v42, v29, v44, 0 op_sel:[0,0,0] op_sel_hi:[1,0,0]
    v_fma_mix_f32 v43, v29, v44, 0 op_sel:[1,0,0] op_sel_hi:[1,0,0]
    s_waitcnt vmcnt(2)
    v_xor_b32 v31, v124, v31
    v_fma_mix_f32 v40, v30, v45, v40 op_sel:[0,0,0] op_sel_hi:[1,0,0]
    v_fma_mix_f32 v41, v30, v45, v41 op_sel:[1,0,0] op_sel_hi:[1,0,0]
    v_fma_mix_f32 v42, v31, v45, v42 op_sel:[0,0,0] op_sel_hi:[1,0,0]
    v_fma_mix_f32 v43, v31, v45, v43 op_sel:[1,0,0] op_sel_hi:[1,0,0]
    v_max_f32 v40, 0, v40
    v_max_f32 v41, 0, v41
    v_max_f32 v42, 0, v42
    v_max_f32 v43, 0, v43
    s_waitcnt vmcnt(1)
    v_xor_b32 v33, v124, v33
    v_or3_b32 v6, v28, v30, v32
    v_or3_b32 v7, v29, v31, v33
    v_fma_mix_f32 v36, v32, v46, 0 op_sel:[0,0,0] op_sel_hi:[1,0,0]
    v_fma_mix_f32 v37, v32, v46, 0 op_sel:[1,0,0] op_sel_hi:[1,0,0]
    v_fma_mix_f32 v38, v33, v46, 0 op_sel:[0,0,0] op_sel_hi:[1,0,0]
    v_fma_mix_f32 v39, v33, v46, 0 op_sel:[1,0,0] op_sel_hi:[1,0,0]
    s_waitcnt vmcnt(0)
    v_xor_b32 v35, v124, v35
    v_or_b32 v6, v6, v34
    v_bitop3_b32 v7, v7, v35, s60 bitop3:0xa8
    v_and_or_b32 v6, v6, s56, v7
    v_cmp_ne_u32 vcc, 0, v6
    v_fma_mix_f32 v36, v34, v47, v36 op_sel:[0,0,0] op_sel_hi:[1,0,0]
    v_fma_mix_f32 v37, v34, v47, v37 op_sel:[1,0,0] op_sel_hi:[1,0,0]
    v_fma_mix_f32 v38, v35, v47, v38 op_sel:[0,0,0] op_sel_hi:[1,0,0]
    v_fma_mix_f32 v39, v35, v47, v39 op_sel:[1,0,0] op_sel_hi:[1,0,0]
    v_pk_mul_f32 v[40:41], v[40:41], v[36:37]
    v_pk_mul_f32 v[42:43], v[42:43], v[38:39]
    s_cbranch_vccz L_gad_84
    v_cmp_ne_u32 vcc, 0, v7
    s_cbranch_vccnz L_gar_86
    s_mov_b32 s56, 0
    s_call_b64 s[6:7], L_fixr
    s_branch L_gac_85
L_gar_86:
    s_cmp_le_u32 s67, 100000
    s_cbranch_scc1 L_ga_83
L_gad_84:
L_late:
    v_cvt_pk_bf16_f32 v28, v40, v41
    v_cvt_pk_bf16_f32 v29, v42, v43
    ds_write_b64 v121, v[28:29]
    s_cmp_ge_u32 s52, 27
    s_cbranch_scc1 L_late_bar
    s_cmp_ge_u32 s62, 26
    s_cbranch_scc1 L_wpd_92
L_wp_91:
    ds_read_b32 v6, v9 offset:0
    s_waitcnt lgkmcnt(0)
    v_readfirstlane_b32 s62, v6
    s_cmp_ge_u32 s62, 26
    s_cbranch_scc0 L_wp_91
L_wpd_92:
    s_cmp_lt_u32 s62, s52
    s_cbranch_scc1 L_wc_93
    s_call_b64 s[6:7], L_wcatch
L_wc_93:
L_late_bar:
    s_cmp_eq_u32 s52, 99
    s_waitcnt lgkmcnt(0)
    s_barrier
    s_cbranch_scc1 L_late_act
    ds_read_b64_tr_b16 v[76:77], v10 offset:49152
    ds_read_b64_tr_b16 v[78:79], v10 offset:50176
    ds_read_b64_tr_b16 v[80:81], v10 offset:57344
    ds_read_b64_tr_b16 v[82:83], v10 offset:58368
L_late_act:
    ds_read_b128 v[84:87], v11 offset:0
    ds_read_b128 v[88:91], v12 offset:512
    ds_read_b128 v[92:95], v11 offset:1024
    ds_read_b128 v[96:99], v12 offset:1536
    ds_read_b128 v[100:103], v11 offset:2048
    ds_read_b128 v[104:107], v12 offset:2560
    ds_read_b128 v[108:111], v11 offset:3072
    ds_read_b128 v[112:115], v12 offset:3584
    s_waitcnt lgkmcnt(7)
    v_mfma_f32_16x16x32_bf16 v[20:23], v[52:55], v[84:87], 0
    s_waitcnt lgkmcnt(6)
    v_mfma_f32_16x16x32_bf16 v[20:23], v[56:59], v[88:91], v[20:23]
    s_waitcnt lgkmcnt(5)
    v_mfma_f32_16x16x32_bf16 v[20:23], v[60:63], v[92:95], v[20:23]
    s_waitcnt lgkmcnt(4)
    v_mfma_f32_16x16x32_bf16 v[20:23], v[64:67], v[96:99], v[20:23]
    s_waitcnt lgkmcnt(3)
    v_mfma_f32_16x16x32_bf16 v[20:23], v[68:71], v[100:103], v[20:23]
    s_waitcnt lgkmcnt(2)
    v_mfma_f32_16x16x32_bf16 v[20:23], v[72:75], v[104:107], v[20:23]
    s_waitcnt lgkmcnt(1)
    v_mfma_f32_16x16x32_bf16 v[20:23], v[76:79], v[108:111], v[20:23]
    s_waitcnt lgkmcnt(0)
    v_mfma_f32_16x16x32_bf16 v[20:23], v[80:83], v[112:115], v[20:23]
L_late_done:
    s_nop 7
    v_pk_mul_f32 v[20:21], v[20:21], s[58:59] op_sel_hi:[1,0]
    v_pk_mul_f32 v[22:23], v[22:23], s[58:59] op_sel_hi:[1,0]
    v_max3_f32 v6, |v20|, |v21|, |v22|
    v_max_f32 v6, |v23|, v6
    v_subrev_u32 v7, 0x39800000, v6
    v_cmp_le_u32 vcc, s57, v7
L_er_95:
    v_cvt_pkrtz_f16_f32 v50, v20, v21
    v_cvt_pkrtz_f16_f32 v51, v22, v23
    v_add_u32 v50, 0x00020002, v50
    v_add_u32 v51, 0x00020002, v51
    v_and_or_b32 v50, v50, s61, v49
    v_and_or_b32 v51, v51, s61, v123
    s_cbranch_vccz L_en_94
    s_call_b64 s[6:7], L_encs
    s_branch L_er_95
L_en_94:
    s_mov_b32 exec_lo, 0x00ff00ff
    s_mov_b32 exec_hi, 0x00ff00ff
    global_store_dwordx2 v5, v[50:51], s[12:13] sc1
    s_mov_b64 exec, -1
    s_cmp_ge_u32 s43, 16
    s_cbranch_scc1 L_red
    s_branch L_exit
L_red:
    s_mov_b64 s[68:69], s[10:11]
    v_mov_b32 v44, v116
    s_mov_b32 s56, s60
    s_mov_b32 s67, 0
L_ga_96:
    global_load_dwordx2 v[28:29], v125, s[68:69] offset:0 sc1
L_gac_98:
    s_add_u32 s67, s67, 1
    s_waitcnt vmcnt(0)
    v_xor_b32 v29, v124, v29
    v_and_b32 v7, s60, v29
    v_and_or_b32 v6, v28, s56, v7
    v_cmp_ne_u32 vcc, 0, v6
    v_fma_mix_f32 v40, v28, v44, 0 op_sel:[0,0,0] op_sel_hi:[1,0,0]
    v_fma_mix_f32 v41, v28, v44, 0 op_sel:[1,0,0] op_sel_hi:[1,0,0]
    v_fma_mix_f32 v42, v29, v44, 0 op_sel:[0,0,0] op_sel_hi:[1,0,0]
    v_fma_mix_f32 v43, v29, v44, 0 op_sel:[1,0,0] op_sel_hi:[1,0,0]
    s_cbranch_vccz L_gad_97
    v_cmp_ne_u32 vcc, 0, v7
    s_cbranch_vccnz L_gar_99
    s_mov_b32 s56, 0
    s_call_b64 s[6:7], L_fixr
    s_branch L_gac_98
L_gar_99:
    s_cmp_le_u32 s67, 100000
    s_cbranch_scc1 L_ga_96
L_gad_97:
    s_nop 1
    v_permlane32_swap_b32 v40, v42
    v_permlane32_swap_b32 v41, v43
    v_add_f32 v40, v40, v42
    v_add_f32 v41, v41, v43
    s_nop 1
    v_permlane16_swap_b32 v40, v41
    v_add_f32 v28, v40, v41
    ds_write_b32 v117, v28
    s_mov_b64 exec, 1
    ds_add_rtn_u32 v6, v9, v120 offset:32
    s_mov_b64 exec, -1
    ds_read2st64_b32 v[28:29], v118 offset0:0 offset1:1
    ds_read2st64_b32 v[30:31], v118 offset0:2 offset1:3
    ds_read2st64_b32 v[32:33], v118 offset0:4 offset1:5
    ds_read2st64_b32 v[34:35], v118 offset0:6 offset1:7
    s_waitcnt lgkmcnt(4)
    v_readfirstlane_b32 s64, v6
    s_cmp_lg_u32 s64, 7
    s_cbranch_scc1 L_exit
    s_waitcnt lgkmcnt(0)
    v_pk_add_f32 v[28:29], v[28:29], v[30:31]
    v_pk_add_f32 v[32:33], v[32:33], v[34:35]
    v_pk_add_f32 v[28:29], v[28:29], v[32:33]
    v_add_f32 v28, v28, v29
    v_cvt_pk_bf16_f32 v28, v28, v28
    global_store_short v119, v28, s[36:37] sc1
    s_cmp_lg_u32 s2, 128
    s_cbranch_scc1 L_noepoch
    s_mov_b64 exec, 1
    v_mov_b32 v6, 0
    global_store_dword v6, v4, s[40:41] sc1
    s_mov_b64 exec, -1
L_noepoch:
    s_branch L_exit
L_wcatch:
    s_cmp_gt_u32 s52, 21
    s_cbranch_scc1 L_wcn0
    ds_read_b64_tr_b16 v[52:53], v10 offset:0
    ds_read_b64_tr_b16 v[54:55], v10 offset:1024
    s_mov_b32 s52, 22
L_wcn0:
    s_cmp_gt_u32 s52, 22
    s_cbranch_scc1 L_wcn1
    s_cmp_lt_u32 s62, s52
    s_cbranch_scc1 L_wcret
    ds_read_b64_tr_b16 v[56:57], v10 offset:8192
    ds_read_b64_tr_b16 v[58:59], v10 offset:9216
    s_mov_b32 s52, 23
L_wcn1:
    s_cmp_gt_u32 s52, 23
    s_cbranch_scc1 L_wcn2
    s_cmp_lt_u32 s62, s52
    s_cbranch_scc1 L_wcret
    ds_read_b64_tr_b16 v[60:61], v10 offset:16384
    ds_read_b64_tr_b16 v[62:63], v10 offset:17408
    s_mov_b32 s52, 24
L_wcn2:
    s_cmp_gt_u32 s52, 24
    s_cbranch_scc1 L_wcn3
    s_cmp_lt_u32 s62, s52
    s_cbranch_scc1 L_wcret
    ds_read_b64_tr_b16 v[64:65], v10 offset:24576
    ds_read_b64_tr_b16 v[66:67], v10 offset:25600
    s_mov_b32 s52, 25
L_wcn3:
    s_cmp_gt_u32 s52, 25
    s_cbranch_scc1 L_wcn4
    s_cmp_lt_u32 s62, s52
    s_cbranch_scc1 L_wcret
    ds_read_b64_tr_b16 v[68:69], v10 offset:32768
    ds_read_b64_tr_b16 v[70:71], v10 offset:33792
    s_mov_b32 s52, 26
L_wcn4:
    s_cmp_gt_u32 s52, 26
    s_cbranch_scc1 L_wcn5
    s_cmp_lt_u32 s62, s52
    s_cbranch_scc1 L_wcret
    ds_read_b64_tr_b16 v[72:73], v10 offset:40960
    ds_read_b64_tr_b16 v[74:75], v10 offset:41984
    s_mov_b32 s52, 27
L_wcn5:
    s_cmp_gt_u32 s52, 27
    s_cbranch_scc1 L_wcn6
    s_cmp_lt_u32 s62, s52
    s_cbranch_scc1 L_wcret
    ds_read_b64_tr_b16 v[76:77], v10 offset:49152
    ds_read_b64_tr_b16 v[78:79], v10 offset:50176
    s_mov_b32 s52, s14
L_wcn6:
    s_cmp_lt_u32 s62, s52
    s_cbranch_scc1 L_wcret
    ds_read_b64_tr_b16 v[80:81], v10 offset:57344
    ds_read_b64_tr_b16 v[82:83], v10 offset:58368
    s_mov_b32 s52, 99
L_wcret:
    s_setpc_b64 s[6:7]
L_gate:
    s_cmp_lt_u32 s63, 4
    s_cbranch_scc1 L_bc_late
    s_cmp_ge_u32 s62, 4
    s_cbranch_scc1 L_wpd_101
L_wp_100:
    s_sleep 1
    ds_read_b32 v6, v9 offset:0
    s_waitcnt lgkmcnt(0)
    v_readfirstlane_b32 s62, v6
    s_cmp_ge_u32 s62, 4
    s_cbranch_scc0 L_wp_100
L_wpd_101:
    s_and_b32 s64, s43, 1
    s_lshl2_add_u32 s64, s64, s63
    s_sub_u32 s66, s64, 4
    s_lshl_b32 s64, s66, 11
    v_add_u32 v8, s64, v1
    global_load_dwordx4 v[52:55], v8, s[16:17] offset:0
    global_load_dwordx4 v[60:63], v1, s[34:35] offset:0
    global_load_dwordx4 v[56:59], v8, s[16:17] offset:1024
    global_load_dwordx4 v[64:67], v1, s[34:35] offset:1024
    v_mov_b32 v24, 0
    s_waitcnt vmcnt(0)
    v_lshlrev_b32 v12, 16, v52
    v_and_b32 v13, 0xffff0000, v52
    v_lshlrev_b32 v14, 16, v60
    v_and_b32 v15, 0xffff0000, v60
    v_mul_f32 v12, v12, v14
    v_mul_f32 v13, v13, v15
    v_cvt_pk_bf16_f32 v12, v12, v13
    v_lshlrev_b32 v13, 16, v12
    v_and_b32 v12, 0xffff0000, v12
    v_add_f32 v24, v24, v13
    v_add_f32 v24, v24, v12
    v_lshlrev_b32 v12, 16, v53
    v_and_b32 v13, 0xffff0000, v53
    v_lshlrev_b32 v14, 16, v61
    v_and_b32 v15, 0xffff0000, v61
    v_mul_f32 v12, v12, v14
    v_mul_f32 v13, v13, v15
    v_cvt_pk_bf16_f32 v12, v12, v13
    v_lshlrev_b32 v13, 16, v12
    v_and_b32 v12, 0xffff0000, v12
    v_add_f32 v24, v24, v13
    v_add_f32 v24, v24, v12
    v_lshlrev_b32 v12, 16, v54
    v_and_b32 v13, 0xffff0000, v54
    v_lshlrev_b32 v14, 16, v62
    v_and_b32 v15, 0xffff0000, v62
    v_mul_f32 v12, v12, v14
    v_mul_f32 v13, v13, v15
    v_cvt_pk_bf16_f32 v12, v12, v13
    v_lshlrev_b32 v13, 16, v12
    v_and_b32 v12, 0xffff0000, v12
    v_add_f32 v24, v24, v13
    v_add_f32 v24, v24, v12
    v_lshlrev_b32 v12, 16, v55
    v_and_b32 v13, 0xffff0000, v55
    v_lshlrev_b32 v14, 16, v63
    v_and_b32 v15, 0xffff0000, v63
    v_mul_f32 v12, v12, v14
    v_mul_f32 v13, v13, v15
    v_cvt_pk_bf16_f32 v12, v12, v13
    v_lshlrev_b32 v13, 16, v12
    v_and_b32 v12, 0xffff0000, v12
    v_add_f32 v24, v24, v13
    v_add_f32 v24, v24, v12
    v_lshlrev_b32 v12, 16, v56
    v_and_b32 v13, 0xffff0000, v56
    v_lshlrev_b32 v14, 16, v64
    v_and_b32 v15, 0xffff0000, v64
    v_mul_f32 v12, v12, v14
    v_mul_f32 v13, v13, v15
    v_cvt_pk_bf16_f32 v12, v12, v13
    v_lshlrev_b32 v13, 16, v12
    v_and_b32 v12, 0xffff0000, v12
    v_add_f32 v24, v24, v13
    v_add_f32 v24, v24, v12
    v_lshlrev_b32 v12, 16, v57
    v_and_b32 v13, 0xffff0000, v57
    v_lshlrev_b32 v14, 16, v65
    v_and_b32 v15, 0xffff0000, v65
    v_mul_f32 v12, v12, v14
    v_mul_f32 v13, v13, v15
    v_cvt_pk_bf16_f32 v12, v12, v13
    v_lshlrev_b32 v13, 16, v12
    v_and_b32 v12, 0xffff0000, v12
    v_add_f32 v24, v24, v13
    v_add_f32 v24, v24, v12
    v_lshlrev_b32 v12, 16, v58
    v_and_b32 v13, 0xffff0000, v58
    v_lshlrev_b32 v14, 16, v66
    v_and_b32 v15, 0xffff0000, v66
    v_mul_f32 v12, v12, v14
    v_mul_f32 v13, v13, v15
    v_cvt_pk_bf16_f32 v12, v12, v13
    v_lshlrev_b32 v13, 16, v12
    v_and_b32 v12, 0xffff0000, v12
    v_add_f32 v24, v24, v13
    v_add_f32 v24, v24, v12
    v_lshlrev_b32 v12, 16, v59
    v_and_b32 v13, 0xffff0000, v59
    v_lshlrev_b32 v14, 16, v67
    v_and_b32 v15, 0xffff0000, v67
    v_mul_f32 v12, v12, v14
    v_mul_f32 v13, v13, v15
    v_cvt_pk_bf16_f32 v12, v12, v13
    v_lshlrev_b32 v13, 16, v12
    v_and_b32 v12, 0xffff0000, v12
    v_add_f32 v24, v24, v13
    v_add_f32 v24, v24, v12
    ds_swizzle_b32 v12, v24 offset:0x41f
    s_waitcnt lgkmcnt(0)
    v_add_f32 v24, v24, v12
    ds_swizzle_b32 v12, v24 offset:0x81f
    s_waitcnt lgkmcnt(0)
    v_add_f32 v24, v24, v12
    ds_swizzle_b32 v12, v24 offset:0x101f
    s_waitcnt lgkmcnt(0)
    v_add_f32 v24, v24, v12
    ds_swizzle_b32 v12, v24 offset:0x201f
    s_waitcnt lgkmcnt(0)
    v_add_f32 v24, v24, v12
    ds_swizzle_b32 v12, v24 offset:0x401f
    s_waitcnt lgkmcnt(0)
    v_add_f32 v24, v24, v12
    v_mov_b32 v12, v24
    s_nop 1
    v_permlane32_swap_b32 v24, v12
    v_add_f32 v24, v24, v12
    v_cvt_pk_bf16_f32 v24, v24, v24
    v_and_b32 v24, 0xffff0000, v24
    v_mul_f32 v24, 0xbfb8aa3b, v24
    v_exp_f32 v24, v24
    s_nop 0
    v_add_f32 v24, 1.0, v24
    v_rcp_f32 v24, v24
    s_nop 0
    v_cvt_pk_bf16_f32 v24, v24, v24
    v_and_b32 v24, 0xffff0000, v24
    s_and_b32 s64, s43, 1
    s_lshl1_add_u32 s64, s42, s64
    s_lshl4_add_u32 s64, s64, s63
    s_lshl_b32 s64, s64, 3
    s_add_u32 s64, s64, 32736
    v_mov_b32 v7, s64
    v_mov_b32 v25, s54
    s_mov_b64 exec, 1
    global_store_dwordx2 v7, v[24:25], s[40:41] sc1
    s_mov_b64 exec, -1
    s_branch L_bc_late
L_encs:
    v_lshrrev_b32 v6, 23, v6
    v_subrev_u32 v6, 126, v6
    v_ashrrev_i32 v6, 4, v6
    v_med3_i32 v6, v6, -8, 7
    v_cndmask_b32 v6, 0, v6, vcc
    v_and_b32 v49, 15, v6
    v_lshl_or_b32 v49, v49, 14, v49
    v_and_b32 v49, s60, v49
    v_mul_i32_i24 v6, -16, v6
    v_ldexp_f32 v20, v20, v6
    v_ldexp_f32 v21, v21, v6
    v_ldexp_f32 v22, v22, v6
    v_ldexp_f32 v23, v23, v6
    s_mov_b64 vcc, 0
    s_setpc_b64 s[6:7]
L_fixr:
    v_xor_b32 v29, v124, v29
    v_xor_b32 v31, v124, v31
    v_xor_b32 v33, v124, v33
    v_xor_b32 v35, v124, v35
L_fix:
    v_and_b32 v6, 3, v28
    v_bfe_i32 v7, v28, 16, 2
    v_lshl_or_b32 v6, v7, 2, v6
    v_lshlrev_b32 v6, 4, v6
    v_ldexp_f32 v44, v44, v6
    v_and_b32 v6, 3, v30
    v_bfe_i32 v7, v30, 16, 2
    v_lshl_or_b32 v6, v7, 2, v6
    v_lshlrev_b32 v6, 4, v6
    v_ldexp_f32 v45, v45, v6
    v_and_b32 v6, 3, v32
    v_bfe_i32 v7, v32, 16, 2
    v_lshl_or_b32 v6, v7, 2, v6
    v_lshlrev_b32 v6, 4, v6
    v_ldexp_f32 v46, v46, v6
    v_and_b32 v6, 3, v34
    v_bfe_i32 v7, v34, 16, 2
    v_lshl_or_b32 v6, v7, 2, v6
    v_lshlrev_b32 v6, 4, v6
    v_ldexp_f32 v47, v47, v6
    s_setpc_b64 s[6:7]
L_notif:
    s_cmp_eq_u32 s44, 2
    s_cbranch_scc1 L_exit
    s_cmp_ge_u32 s43, 16
    s_cbranch_scc1 L_notifM
    s_and_b32 s64, s46, -4
    s_or_b32 s65, s46, 3
    s_mul_i32 s64, s64, 147
    s_mul_i32 s65, s65, 147
    s_lshr_b32 s64, s64, 10
    s_lshr_b32 s65, s65, 10
    s_cmp_eq_u32 s64, s65
    s_cselect_b32 s9, 2, 4
    s_mul_i32 s64, s64, 1280
    s_add_u32 s64, s64, 262144
    s_add_u32 s70, s40, s64
    s_addc_u32 s71, s41, 0
    s_cmp_ge_u32 s62, 19
    s_cbranch_scc1 L_wpd_103
L_wp_102:
    s_sleep 2
    ds_read_b32 v6, v9 offset:0
    s_waitcnt lgkmcnt(0)
    v_readfirstlane_b32 s62, v6
    s_cmp_ge_u32 s62, 19
    s_cbranch_scc0 L_wp_102
L_wpd_103:
    s_cmp_ge_u32 s62, 20
    s_cbranch_scc1 L_wpd_105
L_wp_104:
    ds_read_b32 v6, v9 offset:0
    s_waitcnt lgkmcnt(0)
    v_readfirstlane_b32 s62, v6
    s_cmp_ge_u32 s62, 20
    s_cbranch_scc0 L_wp_104
L_wpd_105:
    s_mov_b32 s8, 1
    s_atomic_add s8, s[70:71], 0
    s_atomic_add s8, s[70:71], 640
    s_cmp_eq_u32 s9, 2
    s_cbranch_scc1 L_bh_106
    s_atomic_add s8, s[70:71], 1280
    s_atomic_add s8, s[70:71], 1920
L_bh_106:
    s_branch L_exit
L_notifM:
    s_mul_i32 s64, s47, 20480
    s_add_u32 s64, s64, 163840
    s_add_u32 s70, s40, s64
    s_addc_u32 s71, s41, 0
L_w_107:
    s_sleep 2
    ds_read_b32 v6, v9 offset:24
    s_waitcnt lgkmcnt(0)
    v_readfirstlane_b32 s64, v6
    s_cmp_ge_u32 s64, 8
    s_cbranch_scc0 L_w_107
    ds_read_b32 v6, v9 offset:0
    s_waitcnt lgkmcnt(0)
    v_readfirstlane_b32 s62, v6
    s_cmp_lt_u32 s62, 20
    s_cbranch_scc1 L_notifV
L_w_108:
    ds_read_b32 v6, v9 offset:40
    s_waitcnt lgkmcnt(0)
    v_readfirstlane_b32 s64, v6
    s_cmp_ge_u32 s64, 1
    s_cbranch_scc0 L_w_108
L_notifV:
    s_cmp_ge_u32 s62, 19
    s_cbranch_scc1 L_wpd_110
L_wp_109:
    s_sleep 2
    ds_read_b32 v6, v9 offset:0
    s_waitcnt lgkmcnt(0)
    v_readfirstlane_b32 s62, v6
    s_cmp_ge_u32 s62, 19
    s_cbranch_scc0 L_wp_109
L_wpd_110:
    s_cmp_ge_u32 s62, 20
    s_cbranch_scc1 L_wpd_112
L_wp_111:
    ds_read_b32 v6, v9 offset:0
    s_waitcnt lgkmcnt(0)
    v_readfirstlane_b32 s62, v6
    s_cmp_ge_u32 s62, 20
    s_cbranch_scc0 L_wp_111
L_wpd_112:
    s_mov_b32 s8, 1
    s_atomic_add s8, s[70:71], 0
    s_atomic_add s8, s[70:71], 640
    s_atomic_add s8, s[70:71], 1280
    s_atomic_add s8, s[70:71], 1920
    s_atomic_add s8, s[70:71], 2560
    s_atomic_add s8, s[70:71], 3200
    s_atomic_add s8, s[70:71], 3840
    s_atomic_add s8, s[70:71], 4480
    s_branch L_exit
L_poller:
    s_cmp_ge_u32 s43, 16
    s_cbranch_scc1 L_pollM
    s_lshl3_add_u32 s64, s49, s50
    s_and_b32 s64, s64, 7
    s_lshl_b32 s65, s47, 5
    s_add_u32 s64, s64, s65
    s_mul_i32 s64, s64, 640
    s_add_u32 s64, s64, 163840
    s_add_u32 s70, s40, s64
    s_addc_u32 s71, s41, 0
    s_load_dword s4, s[70:71], 0 glc
    s_and_b32 s64, s49, 3
    s_lshl_b32 s64, s64, 4
    s_lshl_b32 s65, s47, 11
    s_add_u32 s64, s64, s65
    s_add_u32 s64, s64, 16384
    s_add_u32 s68, s40, s64
    s_addc_u32 s69, s41, 0
    v_and_b32 v8, 31, v0
    v_lshlrev_b32 v8, 6, v8
    v_lshrrev_b32 v7, 5, v0
    v_lshl_or_b32 v8, v7, 3, v8
    s_waitcnt lgkmcnt(0)
    v_lshl_add_u32 v10, v0, 2, v9
    s_cmp_eq_u32 s44, 2
    s_cselect_b32 s65, 26, 19
    s_add_u32 s5, s4, 32
    s_cmp_ge_u32 s62, s65
    s_cbranch_scc1 L_wpd_114
L_wp_113:
    s_sleep 2
    ds_read_b32 v6, v9 offset:0
    s_waitcnt lgkmcnt(0)
    v_readfirstlane_b32 s62, v6
    s_cmp_ge_u32 s62, s65
    s_cbranch_scc0 L_wp_113
L_wpd_114:
    s_mov_b32 s67, 0
L_pl1:
    s_load_dword s8, s[70:71], 0 glc
    s_add_u32 s67, s67, 1
    s_cmp_gt_u32 s67, 20
    s_waitcnt lgkmcnt(0)
    s_cbranch_scc1 L_pl1d
    s_sub_u32 s9, s8, s4
    s_cmp_lt_u32 s9, 16
    s_cbranch_scc1 L_pl1
L_pl1d:
    s_mov_b32 s9, 0
    s_mov_b32 s66, 0
L_lse:
    global_load_dwordx2 v[44:45], v8, s[68:69] sc1
    s_cmp_lg_u32 s9, 0
    s_cbranch_scc1 L_lse_wait
L_pl2:
    s_cmp_eq_u32 s8, s5
    s_cbranch_scc1 L_pl_sig
    s_cmp_gt_u32 s67, 20
    s_cbranch_scc1 L_pl_sig
    s_getreg_b32 s10, hwreg(HW_REG_IB_STS, 0, 4)
    s_cmp_eq_u32 s10, 0
    s_cbranch_scc1 L_lse_wait
    s_load_dword s8, s[70:71], 0 glc
    s_add_u32 s67, s67, 1
    s_waitcnt lgkmcnt(0)
    s_branch L_pl2
L_pl_sig:
    s_mov_b64 exec, 1
    ds_add_u32 v9, v120 offset:4
    s_mov_b64 exec, -1
    s_mov_b32 s9, 1
L_lse_wait:
    s_load_dword s8, s[70:71], 0 glc
    s_add_u32 s66, s66, 1
    s_waitcnt vmcnt(0)
    v_cmp_ne_u32 vcc, s54, v45
    s_cbranch_vccz L_lsed
    s_cmp_le_u32 s66, 100000
    s_waitcnt lgkmcnt(0)
    s_cbranch_scc1 L_lse
L_lsed:
    v_max_f32_dpp v6, v44, v44 quad_perm:[1,0,3,2] row_mask:0xf bank_mask:0xf
    s_nop 1
    v_max_f32_dpp v6, v6, v6 quad_perm:[2,3,0,1] row_mask:0xf bank_mask:0xf
    v_sub_f32 v44, v44, v6
    v_exp_f32 v44, v44
    s_nop 1
    v_add_f32_dpp v6, v44, v44 quad_perm:[1,0,3,2] row_mask:0xf bank_mask:0xf
    s_nop 1
    v_add_f32_dpp v6, v6, v6 quad_perm:[2,3,0,1] row_mask:0xf bank_mask:0xf
    v_rcp_f32 v6, v6
    s_nop 0
    v_mul_f32 v44, v44, v6
    v_mul_f32 v44, 0x39800000, v44
    ds_write_b32 v10, v44 offset:128
    s_mov_b64 exec, 1
    ds_add_u32 v9, v120 offset:12
    s_mov_b64 exec, -1
    s_cmp_lg_u32 s9, 0
    s_cbranch_scc1 L_pl_fin
    s_waitcnt lgkmcnt(0)
    s_cmp_eq_u32 s8, s5
    s_cbranch_scc1 L_pl_sig2
    s_mov_b32 s67, 0
L_pf_115:
    s_load_dword s8, s[70:71], 0 glc
    s_add_u32 s67, s67, 1
    s_cmp_gt_u32 s67, 20
    s_waitcnt lgkmcnt(0)
    s_cbranch_scc1 L_pfd_116
    s_cmp_eq_u32 s8, s5
    s_cbranch_scc0 L_pf_115
L_pfd_116:
L_pl_sig2:
    s_mov_b64 exec, 1
    ds_add_u32 v9, v120 offset:4
    s_mov_b64 exec, -1
L_pl_fin:
    s_barrier
    s_branch L_exit
L_pollM:
    s_lshl2_add_u32 s64, s51, s48
    s_lshr_b32 s64, s64, 2
    s_lshl_b32 s65, s47, 5
    s_add_u32 s64, s64, s65
    s_mul_i32 s64, s64, 640
    s_add_u32 s64, s64, 65536
    s_add_u32 s70, s40, s64
    s_addc_u32 s71, s41, 0
    s_mul_i32 s64, s49, 2
    s_and_b32 s65, s50, 1
    s_add_u32 s64, s64, s65
    s_mul_i32 s64, s64, 640
    s_add_u32 s64, s64, 262144
    s_add_u32 s68, s40, s64
    s_addc_u32 s69, s41, 0
    s_load_dword s5, s[68:69], 0 glc
    s_bitcmp1_b32 s101, 1
    s_cselect_b32 s64, 12, 8
    s_waitcnt lgkmcnt(0)
    s_add_u32 s4, s4, 64
    s_add_u32 s5, s5, s64
    s_and_b32 s64, s43, 1
    s_lshl1_add_u32 s64, s42, s64
    s_lshl_b32 s64, s64, 7
    s_add_u32 s64, s64, 32768
    s_add_u32 s70, s40, s64
    s_addc_u32 s71, s41, 0
    s_cmp_ge_u32 s62, 13
    s_cbranch_scc1 L_wpd_119
L_wp_118:
    s_sleep 2
    ds_read_b32 v6, v9 offset:0
    s_waitcnt lgkmcnt(0)
    v_readfirstlane_b32 s62, v6
    s_cmp_ge_u32 s62, 13
    s_cbranch_scc0 L_wp_118
L_wpd_119:
    s_mov_b32 s67, 0
L_gp:
    s_load_dwordx8 s[16:23], s[70:71], 0 glc
    s_add_u32 s67, s67, 1
    s_cmp_gt_u32 s67, 100000
    s_waitcnt lgkmcnt(0)
    s_cbranch_scc1 L_gpd
    s_cmp_eq_u32 s17, s54
    s_cbranch_scc0 L_gp
    s_cmp_eq_u32 s19, s54
    s_cbranch_scc0 L_gp
    s_cmp_eq_u32 s21, s54
    s_cbranch_scc0 L_gp
    s_cmp_eq_u32 s23, s54
    s_cbranch_scc0 L_gp
L_gpd:
    v_mov_b32 v28, s16
    v_mov_b32 v29, s18
    v_mov_b32 v30, s20
    v_mov_b32 v31, s22
    s_mov_b64 exec, 1
    ds_write_b128 v9, v[28:31] offset:96
    s_mov_b64 exec, 1
    ds_add_u32 v9, v120 offset:8
    s_mov_b64 exec, -1
    s_cmp_ge_u32 s62, 19
    s_cbranch_scc1 L_wpd_121
L_wp_120:
    s_sleep 2
    ds_read_b32 v6, v9 offset:0
    s_waitcnt lgkmcnt(0)
    v_readfirstlane_b32 s62, v6
    s_cmp_ge_u32 s62, 19
    s_cbranch_scc0 L_wp_120
L_wpd_121:
    s_mov_b32 s67, 0
L_pf_122:
    s_load_dword s8, s[68:69], 0 glc
    s_add_u32 s67, s67, 1
    s_cmp_gt_u32 s67, 20
    s_waitcnt lgkmcnt(0)
    s_cbranch_scc1 L_pfd_123
    s_cmp_eq_u32 s8, s5
    s_cbranch_scc0 L_pf_122
L_pfd_123:
    s_mov_b64 exec, 1
    ds_add_u32 v9, v120 offset:4
    s_mov_b64 exec, -1
    s_barrier
L_exit:
L_end:
    s_endpgm
.section .rodata,"a"
.p2align 6
.amdhsa_kernel gated_mix__sliding_block_cached__glu_gated_reglu__decode_kernel
  .amdhsa_next_free_vgpr 128
  .amdhsa_next_free_sgpr 102
  .amdhsa_accum_offset 128
  .amdhsa_group_segment_fixed_size 0
  .amdhsa_kernarg_size 104
  .amdhsa_user_sgpr_count 2
  .amdhsa_user_sgpr_kernarg_segment_ptr 1
  .amdhsa_system_sgpr_workgroup_id_x 1
.end_amdhsa_kernel
```
